```python
import torch

def _softmax(x, axis=-1):
    return torch.softmax(x, dim=axis)
def _gelu(x):
    return torch.nn.functional.gelu(x, approximate="tanh")
def _silu(x):
    return torch.nn.functional.silu(x)
def _sigmoid(x):
    return torch.sigmoid(x)
def _layernorm(x, axis=-1, eps=1e-5):
    m = x.mean(dim=axis, keepdim=True)
    v = x.var(dim=axis, keepdim=True, unbiased=False)
    return (x - m) / torch.sqrt(v + eps)
def _scatter_add(tgt, idx, src, axis=0):
    return tgt.clone().index_add_(axis, idx, src)
def _segment_sum(src, seg, n):
    out = torch.zeros((n,) + src.shape[1:], dtype=src.dtype)
    return out.index_add_(0, seg, src)
def _pad(x, pw):
    flat = tuple(v for pair in reversed(pw) for v in pair)
    return torch.nn.functional.pad(x, flat)

kernel_name = 'concat_heads__softmax_full_mha__grouped_kv_mqa__prompt'

def setup_inputs():

    _w = (lambda a: (lambda t: t.to(torch.bfloat16) if t.is_floating_point() else t)(torch.as_tensor(a)))
    def _A_setup():
        B, S, D = 1, 2048, 640
        return {
            "x": _w((lambda *s: torch.randn(*s, dtype=torch.bfloat16) * 0.2)(B, S, D)),
            "wqkv": _w((lambda *s: torch.randn(*s, dtype=torch.bfloat16) * 0.2)(D, 3 * D)),
            "wo": _w((lambda *s: torch.randn(*s, dtype=torch.bfloat16) * 0.05)(D, D)),
        }
    _A_in = _A_setup()

    def _B_setup():
        B, S, D, H = 1, 2048, 640, 32
        Dh = D // H
        return {
            "x": _w((lambda *s: torch.randn(*s, dtype=torch.bfloat16) * 0.05)(B, S, D)),
            "wq": _w((lambda *s: torch.randn(*s, dtype=torch.bfloat16) * 0.8)(D, H * Dh)),
            "wk": _w((lambda *s: torch.randn(*s, dtype=torch.bfloat16) * 0.8)(D, Dh)),
            "wv": _w((lambda *s: torch.randn(*s, dtype=torch.bfloat16) * 0.1)(D, Dh)),
            "wo": _w((lambda *s: torch.randn(*s, dtype=torch.bfloat16) * 0.1)(H * Dh, D)),
        }
    _B_in = _B_setup()

    return {
        "A_x": _A_in["x"],
        "A_wqkv": _A_in["wqkv"],
        "A_wo": _A_in["wo"],
        "B_x": _B_in["x"],
        "B_wq": _B_in["wq"],
        "B_wk": _B_in["wk"],
        "B_wv": _B_in["wv"],
        "B_wo": _B_in["wo"],
    }

def reference(A_x, A_wqkv, A_wo, B_x, B_wq, B_wk, B_wv, B_wo):
    def _A_ref(x, wqkv, wo):
        B, S, D = x.shape
        H = 32; Dh = D // H
        qkv = (lambda x, *d: x.permute(*d))((x @ wqkv).reshape(B, S, 3, H, Dh), 2, 0, 3, 1, 4)
        q, k, v = qkv[0], qkv[1], qkv[2]
        scale = Dh ** -0.5
        scores = torch.einsum("bhqd,bhkd->bhqk", q, k) * scale
        p = _softmax(scores, axis=-1)
        o = torch.einsum("bhqk,bhkd->bhqd", p, v)
        return (lambda x, *d: x.permute(*d))(o, 0, 2, 1, 3).reshape(B, S, D) @ wo

    def _B_ref(x, wq, wk, wv, wo):
        B, S, D = x.shape
        H = 32
        Dh = D // H
        q = (lambda x, *d: x.permute(*d))((x @ wq).reshape(B, S, H, Dh), 0, 2, 1, 3)
        k = x @ wk
        v = x @ wv
        scores = torch.einsum("bhqd,bkd->bhqk", q, k) * (Dh ** -0.5)
        p = _softmax(scores, axis=-1)
        o = torch.einsum("bhqk,bkd->bhqd", p, v)
        return (lambda x, *d: x.permute(*d))(o, 0, 2, 1, 3).reshape(B, S, H * Dh) @ wo

    a = _A_ref(A_x, A_wqkv, A_wo)
    b = _B_ref(B_x, B_wq, B_wk, B_wv, B_wo)
    return torch.concatenate([a, b], axis=-1)
```

```asm
; @launch grid=(256,1,1) block=(576,1,1) lds=163840
.amdgcn_target "amdgcn-amd-amdhsa--gfx950"
.text
.globl concat_heads__softmax_full_mha__grouped_kv_mqa__prompt_kernel
.p2align 8
.type concat_heads__softmax_full_mha__grouped_kv_mqa__prompt_kernel,@function
concat_heads__softmax_full_mha__grouped_kv_mqa__prompt_kernel:
    s_cmp_ge_u32 s2, 256
    s_cbranch_scc1 L_end
    s_nop 0
    s_load_dwordx16 s[48:63], s[0:1], 0
    s_load_dwordx4 s[64:67], s[0:1], 64
    s_load_dwordx2 s[68:69], s[0:1], 80
    v_lshrrev_b32 v4, 6, v0
    v_and_b32 v1, 63, v0
    v_readfirstlane_b32 s12, v4
    v_and_b32 v2, 15, v0
    v_bfe_u32 v3, v0, 4, 2
    s_and_b32 s13, s2, 1
    s_bfe_u32 s3, s2, 0x20001
    s_bfe_u32 s6, s2, 0x20003
    s_lshr_b32 s14, s2, 5
    s_lshl_b32 s5, s3, 2
    s_add_u32 s15, s5, s6
    s_lshr_b32 s5, s3, 1
    s_lshl_b32 s5, s5, 3
    s_add_u32 s32, s5, s14
    s_and_b32 s5, s3, 1
    s_lshl_b32 s5, s5, 2
    s_add_u32 s5, s5, s6
    s_lshl_b32 s7, s13, 3
    s_add_u32 s33, s5, s7
    s_add_u32 s94, s6, s14
    s_and_b32 s94, s94, 3
    s_mul_i32 s94, s94, 5
    s_lshr_b32 s94, s94, 1
    s_mov_b32 s10, 268435456
    s_mov_b32 s11, 0x20000
    s_mov_b32 s30, 256
    s_mov_b32 s31, 0x20000
    s_mov_b32 s40, 0x000fffff
    s_mov_b32 s41, 0x000fffff
    s_mov_b32 s42, 0xffff
    s_mov_b32 s43, 0
    s_mov_b32 s44, 0
    s_mov_b32 s45, -1
    s_mov_b32 s36, 0
    s_waitcnt lgkmcnt(0)
    s_mov_b32 s8, s68
    s_mov_b32 s9, s69
    s_mov_b32 s28, s66
    s_mov_b32 s29, s67
    s_cmp_lt_u32 s12, 4
    s_cbranch_scc1 L_comp
    s_cmp_eq_u32 s12, 8
    s_cbranch_scc1 L_aux
    s_sub_u32 s47, s12, 4
    v_lshrrev_b32 v4, 3, v1
    v_and_b32 v5, 7, v1
    v_xor_b32 v6, v5, v4
    v_lshlrev_b32 v6, 4, v6
    s_lshl_b32 s3, s47, 5
    v_add_u32 v7, s3, v4
    v_mul_u32_u24 v7, 1280, v7
    v_add_u32 v8, v7, v6
    v_add_u32 v9, 10240, v8
    v_add_u32 v10, 20480, v8
    v_add_u32 v11, 30720, v8
    s_lshl_b32 s38, s47, 12
    s_mul_i32 s4, s47, 3
    s_lshl_b32 s5, s47, 1
    s_add_u32 s5, s5, 2
    s_min_u32 s91, s4, s5
    s_lshl_b32 s39, s91, 10
    s_add_u32 s39, s39, 16384
    s_mov_b32 s23, 0x20000
    s_mov_b32 s18, 2621440
    s_mov_b32 s19, 0x20000
    s_mov_b32 s35, 0
    s_add_u32 s3, s13, s36
    s_cmp_eq_u32 s3, 1
    s_cselect_b32 s4, s15, s33
    s_mul_i32 s88, s4, 163840
    s_lshl_b32 s4, s94, 7
    s_add_u32 s88, s88, s4
    s_mov_b32 s95, s94
    s_cmp_gt_u32 s13, s36
    s_cselect_b32 s16, s54, s48
    s_cselect_b32 s17, s55, s49
    s_add_u32 m0, s38, 0
    s_nop 0
    buffer_load_dwordx4 v8, s[16:19], s88 offen  lds
    s_add_u32 m0, s38, 1024
    s_nop 0
    buffer_load_dwordx4 v9, s[16:19], s88 offen  lds
    s_add_u32 m0, s38, 2048
    s_nop 0
    buffer_load_dwordx4 v10, s[16:19], s88 offen  lds
    s_add_u32 m0, s38, 3072
    s_nop 0
    buffer_load_dwordx4 v11, s[16:19], s88 offen  lds
    s_add_u32 s3, s91, 0
    s_cmp_ge_u32 s3, 5
    s_cselect_b32 s4, 5, 0
    s_cselect_b32 s5, 32, 0
    s_sub_u32 s4, s3, s4
    s_lshl_b32 s4, s4, 2
    v_add_u32 v4, s4, v3
    v_mul_u32_u24 v5, 205, v4
    v_lshrrev_b32 v5, 10, v5
    v_mul_u32_u24 v6, 5, v5
    v_sub_u32 v4, v4, v6
    v_lshlrev_b32 v4, 5, v4
    v_and_b32 v6, 1, v1
    v_lshl_add_u32 v20, v6, 4, v4
    v_lshrrev_b32 v4, 1, v5
    v_lshlrev_b32 v4, 4, v4
    v_and_b32 v5, 1, v5
    v_lshl_add_u32 v4, v5, 2, v4
    v_bfe_u32 v5, v1, 3, 1
    v_lshl_add_u32 v4, v5, 3, v4
    v_bfe_u32 v5, v1, 1, 2
    v_add3_u32 v16, v4, v5, s5
    s_add_u32 s3, s91, 1
    s_cmp_ge_u32 s3, 5
    s_cselect_b32 s4, 5, 0
    s_cselect_b32 s5, 32, 0
    s_sub_u32 s4, s3, s4
    s_lshl_b32 s4, s4, 2
    v_add_u32 v4, s4, v3
    v_mul_u32_u24 v5, 205, v4
    v_lshrrev_b32 v5, 10, v5
    v_mul_u32_u24 v6, 5, v5
    v_sub_u32 v4, v4, v6
    v_lshlrev_b32 v4, 5, v4
    v_and_b32 v6, 1, v1
    v_lshl_add_u32 v21, v6, 4, v4
    v_lshrrev_b32 v4, 1, v5
    v_lshlrev_b32 v4, 4, v4
    v_and_b32 v5, 1, v5
    v_lshl_add_u32 v4, v5, 2, v4
    v_bfe_u32 v5, v1, 3, 1
    v_lshl_add_u32 v4, v5, 3, v4
    v_bfe_u32 v5, v1, 1, 2
    v_add3_u32 v17, v4, v5, s5
    s_add_u32 s3, s91, 2
    s_cmp_ge_u32 s3, 5
    s_cselect_b32 s4, 5, 0
    s_cselect_b32 s5, 32, 0
    s_sub_u32 s4, s3, s4
    s_lshl_b32 s4, s4, 2
    v_add_u32 v4, s4, v3
    v_mul_u32_u24 v5, 205, v4
    v_lshrrev_b32 v5, 10, v5
    v_mul_u32_u24 v6, 5, v5
    v_sub_u32 v4, v4, v6
    v_lshlrev_b32 v4, 5, v4
    v_and_b32 v6, 1, v1
    v_lshl_add_u32 v22, v6, 4, v4
    v_lshrrev_b32 v4, 1, v5
    v_lshlrev_b32 v4, 4, v4
    v_and_b32 v5, 1, v5
    v_lshl_add_u32 v4, v5, 2, v4
    v_bfe_u32 v5, v1, 3, 1
    v_lshl_add_u32 v4, v5, 3, v4
    v_bfe_u32 v5, v1, 1, 2
    v_add3_u32 v18, v4, v5, s5
    v_and_b32 v6, 1, v1
    v_lshlrev_b32 v6, 3, v6
    v_add_u32 v6, s14, v6
    v_and_b32 v7, 7, v1
    v_add_u32 v7, 32, v7
    s_cmp_eq_u32 s13, 0
    s_cselect_b64 vcc, -1, 0
    s_cselect_b32 s92, 8, 16
    v_cndmask_b32 v6, v7, v6, vcc
    v_lshlrev_b32 v6, 8, v6
    v_add_u32 v24, 17563648, v6
    v_mov_b32 v25, 0
    s_mul_i32 s3, s13, s47
    s_cmp_eq_u32 s3, 0
    s_cselect_b32 s93, 19, 99
    s_add_u32 s3, s13, s36
    s_mul_i32 s4, s14, 160
    s_mul_i32 s5, s32, 160
    s_add_u32 s5, s5, 1280
    s_cmp_eq_u32 s3, 1
    s_cselect_b32 s89, s4, s5
    s_movk_i32 s4, 3840
    s_mov_b32 s5, 2457600
    s_cmp_gt_u32 s13, s36
    s_cselect_b32 s46, 1280, s4
    s_cselect_b32 s22, 819200, s5
    s_cselect_b32 s20, s56, s50
    s_cselect_b32 s21, s57, s51
    s_lshl_b32 s90, s46, 6
    s_mul_i32 s4, s90, s94
    s_add_u32 s89, s89, s4
    s_mul_i32 s96, s90, 10
    v_mad_u32_u24 v12, v16, s46, v20
    v_mad_u32_u24 v13, v17, s46, v21
    v_mad_u32_u24 v14, v18, s46, v22
    s_add_u32 m0, s39, 0
    s_nop 0
    buffer_load_dwordx4 v12, s[20:23], s89 offen  lds
    s_add_u32 m0, s39, 1024
    s_nop 0
    buffer_load_dwordx4 v13, s[20:23], s89 offen  lds
    s_cmp_ge_u32 s47, 2
    s_cbranch_scc1 L_g2_1
    s_add_u32 m0, s39, 2048
    s_nop 0
    buffer_load_dwordx4 v14, s[20:23], s89 offen  lds
L_g2_1:
    s_mov_b32 s34, 0
    s_add_u32 s88, s88, 128
    s_add_u32 s89, s89, s90
    s_add_u32 s95, s95, 1
    s_cmp_eq_u32 s95, 10
    s_cselect_b32 s4, 1280, 0
    s_cselect_b32 s5, s96, 0
    s_cselect_b32 s95, 0, s95
    s_sub_u32 s88, s88, s4
    s_sub_u32 s89, s89, s5
    s_add_u32 s38, s38, 32768
    s_add_u32 s39, s39, 32768
    s_and_b32 s38, s38, 131071
    s_and_b32 s39, s39, 131071
    s_add_u32 s34, s34, 1
L_ld_pro:
    s_add_u32 m0, s38, 0
    s_nop 0
    buffer_load_dwordx4 v8, s[16:19], s88 offen  lds
    s_add_u32 m0, s38, 1024
    s_nop 0
    buffer_load_dwordx4 v9, s[16:19], s88 offen  lds
    s_add_u32 m0, s38, 2048
    s_nop 0
    buffer_load_dwordx4 v10, s[16:19], s88 offen  lds
    s_add_u32 m0, s38, 3072
    s_nop 0
    buffer_load_dwordx4 v11, s[16:19], s88 offen  lds
    s_add_u32 m0, s39, 0
    s_nop 0
    buffer_load_dwordx4 v12, s[20:23], s89 offen  lds
    s_add_u32 m0, s39, 1024
    s_nop 0
    buffer_load_dwordx4 v13, s[20:23], s89 offen  lds
    s_cmp_ge_u32 s47, 2
    s_cbranch_scc1 L_g2_2
    s_add_u32 m0, s39, 2048
    s_nop 0
    buffer_load_dwordx4 v14, s[20:23], s89 offen  lds
L_g2_2:
    s_add_u32 s88, s88, 128
    s_add_u32 s89, s89, s90
    s_add_u32 s95, s95, 1
    s_cmp_eq_u32 s95, 10
    s_cselect_b32 s4, 1280, 0
    s_cselect_b32 s5, s96, 0
    s_cselect_b32 s95, 0, s95
    s_sub_u32 s88, s88, s4
    s_sub_u32 s89, s89, s5
    s_add_u32 s38, s38, 32768
    s_add_u32 s39, s39, 32768
    s_and_b32 s38, s38, 131071
    s_and_b32 s39, s39, 131071
    s_add_u32 s34, s34, 1
    s_cmp_lt_u32 s34, 4
    s_cbranch_scc1 L_ld_pro
    s_waitcnt vmcnt(18)
    s_barrier
L_ld_loop:
    s_cmp_lg_u32 s34, 10
    s_cbranch_scc1 L_ld_same
    s_mov_b32 s36, 1
    s_add_u32 s3, s13, s36
    s_cmp_eq_u32 s3, 1
    s_cselect_b32 s4, s15, s33
    s_mul_i32 s88, s4, 163840
    s_lshl_b32 s4, s94, 7
    s_add_u32 s88, s88, s4
    s_mov_b32 s95, s94
    s_cmp_gt_u32 s13, s36
    s_cselect_b32 s16, s54, s48
    s_cselect_b32 s17, s55, s49
    s_add_u32 s3, s13, s36
    s_mul_i32 s4, s14, 160
    s_mul_i32 s5, s32, 160
    s_add_u32 s5, s5, 1280
    s_cmp_eq_u32 s3, 1
    s_cselect_b32 s89, s4, s5
    s_movk_i32 s4, 3840
    s_mov_b32 s5, 2457600
    s_cmp_gt_u32 s13, s36
    s_cselect_b32 s46, 1280, s4
    s_cselect_b32 s22, 819200, s5
    s_cselect_b32 s20, s56, s50
    s_cselect_b32 s21, s57, s51
    s_lshl_b32 s90, s46, 6
    s_mul_i32 s4, s90, s94
    s_add_u32 s89, s89, s4
    s_mul_i32 s96, s90, 10
    v_mad_u32_u24 v12, v16, s46, v20
    v_mad_u32_u24 v13, v17, s46, v21
    v_mad_u32_u24 v14, v18, s46, v22
L_ld_same:
    s_waitcnt vmcnt(12)
    s_barrier
    s_cmp_lg_u32 s34, 13
    s_cbranch_scc1 L_ld_noq
    s_cmp_eq_u32 s13, 0
    s_cbranch_scc1 L_ld_noq
    s_mul_i32 s3, s12, 2560
    s_add_u32 s3, s3, 131072
    v_lshlrev_b32 v4, 4, v1
    v_add_u32 v4, s3, v4
    v_and_b32 v5, 31, v1
    v_lshlrev_b32 v5, 3, v5
    v_add_u32 v5, s3, v5
    ds_read_b128 v[148:151], v4
    ds_read_b64 v[156:157], v5 offset:1024
    ds_read_b128 v[152:155], v4 offset:1280
    ds_read_b64 v[158:159], v5 offset:2304
    s_waitcnt lgkmcnt(0)
L_ld_noq:
    s_cmp_lg_u32 s34, s93
    s_cbranch_scc1 L_ld_nop
    buffer_load_dword v25, v24, s[8:11], 0 offen sc1
L_ld_nop:
    s_add_u32 m0, s38, 0
    s_nop 0
    buffer_load_dwordx4 v8, s[16:19], s88 offen  lds
    s_add_u32 m0, s38, 1024
    s_nop 0
    buffer_load_dwordx4 v9, s[16:19], s88 offen  lds
    s_add_u32 m0, s38, 2048
    s_nop 0
    buffer_load_dwordx4 v10, s[16:19], s88 offen  lds
    s_add_u32 m0, s38, 3072
    s_nop 0
    buffer_load_dwordx4 v11, s[16:19], s88 offen  lds
    s_add_u32 m0, s39, 0
    s_nop 0
    buffer_load_dwordx4 v12, s[20:23], s89 offen  lds
    s_add_u32 m0, s39, 1024
    s_nop 0
    buffer_load_dwordx4 v13, s[20:23], s89 offen  lds
    s_cmp_ge_u32 s47, 2
    s_cbranch_scc1 L_g2_3
    s_add_u32 m0, s39, 2048
    s_nop 0
    buffer_load_dwordx4 v14, s[20:23], s89 offen  lds
L_g2_3:
    s_add_u32 s88, s88, 128
    s_add_u32 s89, s89, s90
    s_add_u32 s95, s95, 1
    s_cmp_eq_u32 s95, 10
    s_cselect_b32 s4, 1280, 0
    s_cselect_b32 s5, s96, 0
    s_cselect_b32 s95, 0, s95
    s_sub_u32 s88, s88, s4
    s_sub_u32 s89, s89, s5
    s_add_u32 s38, s38, 32768
    s_add_u32 s39, s39, 32768
    s_and_b32 s38, s38, 131071
    s_and_b32 s39, s39, 131071
    s_add_u32 s34, s34, 1
    s_cmp_lt_u32 s34, 20
    s_cbranch_scc1 L_ld_loop
    s_lshl_b32 s3, s14, 2
    s_cmp_eq_u32 s13, 0
    s_cselect_b32 s3, s3, 32
    s_cselect_b32 s22, 4, 1
    s_mul_i32 s20, s3, 212992
    s_add_u32 s20, s20, 10485760
    v_lshlrev_b32 v8, 4, v1
    s_cmp_ge_u32 s47, s22
    s_cbranch_scc1 L_ld_idle0
    s_mul_i32 s3, s47, 212992
    s_add_u32 s21, s20, s3
    s_mul_i32 s23, s47, 3344
    v_mul_u32_u24 v4, 43, v1
    v_lshrrev_b32 v4, 9, v4
    v_mul_u32_u24 v5, 12, v4
    v_sub_u32 v5, v1, v5
    v_lshlrev_b32 v4, 9, v4
    v_lshl_add_u32 v4, v5, 4, v4
    v_add_u32 v4, 1344, v4
    v_min_u32 v4, 3328, v4
    v_add_u32 v9, s23, v4
    v_cmp_eq_u32 vcc, 0, v5
    v_mov_b32 v6, 0x3f803f80
    v_mov_b32 v7, 0x3f80
    v_cndmask_b32 v12, 0, v6, vcc
    v_cndmask_b32 v14, 0, v6, vcc
    v_cndmask_b32 v15, 0, v6, vcc
    v_cmp_eq_u32 vcc, 48, v1
    s_nop 1
    v_cndmask_b32 v13, v12, v7, vcc
    v_add_u32 v10, 53504, v9
    s_waitcnt vmcnt(12)
    s_barrier
    s_waitcnt vmcnt(6)
    v_cmp_ne_u32 vcc, s92, v25
    s_and_b32 s3, vcc_lo, 0xff
    s_cbranch_scc1 L_ld_slow
    s_add_u32 m0, s23, 0
    s_mov_b64 exec, s[40:41]
    buffer_load_dwordx4 v8, s[8:11], s21 offen offset:1024 sc1 lds
    buffer_load_dwordx4 v8, s[8:11], s21 offen offset:2048 sc1 lds
    s_mov_b64 exec, s[42:43]
    buffer_load_dwordx4 v8, s[8:11], s21 offen offset:3072 sc1 lds
    s_mov_b64 exec, -1
    buffer_load_dwordx4 v8, s[8:11], s21 offen sc1 lds
    s_add_u32 s21, s21, 3328
    s_add_u32 m0, s23, 13376
    s_mov_b64 exec, s[40:41]
    buffer_load_dwordx4 v8, s[8:11], s21 offen offset:1024 sc1 lds
    buffer_load_dwordx4 v8, s[8:11], s21 offen offset:2048 sc1 lds
    s_mov_b64 exec, s[42:43]
    buffer_load_dwordx4 v8, s[8:11], s21 offen offset:3072 sc1 lds
    s_mov_b64 exec, -1
    buffer_load_dwordx4 v8, s[8:11], s21 offen sc1 lds
    s_add_u32 s21, s21, 3328
    s_mov_b32 exec_hi, 0x1ffff
    ds_write_b128 v9, v[12:15] offset:0
    ds_write_b128 v9, v[12:15] offset:13376
    s_mov_b32 exec_hi, -1
    s_barrier
    s_add_u32 m0, s23, 26752
    s_mov_b64 exec, s[40:41]
    buffer_load_dwordx4 v8, s[8:11], s21 offen offset:1024 sc1 lds
    buffer_load_dwordx4 v8, s[8:11], s21 offen offset:2048 sc1 lds
    s_mov_b64 exec, s[42:43]
    buffer_load_dwordx4 v8, s[8:11], s21 offen offset:3072 sc1 lds
    s_mov_b64 exec, -1
    buffer_load_dwordx4 v8, s[8:11], s21 offen sc1 lds
    s_add_u32 s21, s21, 3328
    s_add_u32 m0, s23, 40128
    s_mov_b64 exec, s[40:41]
    buffer_load_dwordx4 v8, s[8:11], s21 offen offset:1024 sc1 lds
    buffer_load_dwordx4 v8, s[8:11], s21 offen offset:2048 sc1 lds
    s_mov_b64 exec, s[42:43]
    buffer_load_dwordx4 v8, s[8:11], s21 offen offset:3072 sc1 lds
    s_mov_b64 exec, -1
    buffer_load_dwordx4 v8, s[8:11], s21 offen sc1 lds
    s_add_u32 s21, s21, 3328
    s_mov_b32 exec_hi, 0x1ffff
    ds_write_b128 v9, v[12:15] offset:26752
    ds_write_b128 v9, v[12:15] offset:40128
    s_mov_b32 exec_hi, -1
    s_waitcnt vmcnt(16)
    s_barrier
    s_add_u32 m0, s23, 53504
    s_mov_b64 exec, s[40:41]
    buffer_load_dwordx4 v8, s[8:11], s21 offen offset:1024 sc1 lds
    buffer_load_dwordx4 v8, s[8:11], s21 offen offset:2048 sc1 lds
    s_mov_b64 exec, s[42:43]
    buffer_load_dwordx4 v8, s[8:11], s21 offen offset:3072 sc1 lds
    s_mov_b64 exec, -1
    buffer_load_dwordx4 v8, s[8:11], s21 offen sc1 lds
    s_add_u32 s21, s21, 3328
    s_barrier
    s_branch L_ld_fin
L_ld_slow:
    s_mov_b32 exec_hi, 0x1ffff
    ds_write_b128 v9, v[12:15] offset:0
    ds_write_b128 v9, v[12:15] offset:13376
    s_mov_b32 exec_hi, -1
    s_barrier
    buffer_load_dword v25, v24, s[8:11], 0 offen sc1
    s_mov_b32 exec_hi, 0x1ffff
    ds_write_b128 v9, v[12:15] offset:26752
    ds_write_b128 v9, v[12:15] offset:40128
    s_mov_b32 exec_hi, -1
    s_waitcnt vmcnt(1)
    s_barrier
    s_mov_b32 s4, 0
L_pollL:
    s_waitcnt vmcnt(0)
    v_cmp_ne_u32 vcc, s92, v25
    s_add_u32 s4, s4, 1
    s_cmp_gt_u32 s4, 60000
    s_cbranch_scc1 L_pollL_t
    s_and_b32 s3, vcc_lo, 0xff
    s_cbranch_scc0 L_pollL_d
    s_sleep 1
    buffer_load_dword v25, v24, s[8:11], 0 offen sc1
    s_branch L_pollL
L_pollL_t:
L_pollL_d:
    s_add_u32 m0, s23, 0
    s_mov_b64 exec, s[40:41]
    buffer_load_dwordx4 v8, s[8:11], s21 offen offset:1024 sc1 lds
    buffer_load_dwordx4 v8, s[8:11], s21 offen offset:2048 sc1 lds
    s_mov_b64 exec, s[42:43]
    buffer_load_dwordx4 v8, s[8:11], s21 offen offset:3072 sc1 lds
    s_mov_b64 exec, -1
    buffer_load_dwordx4 v8, s[8:11], s21 offen sc1 lds
    s_add_u32 s21, s21, 3328
    s_add_u32 m0, s23, 13376
    s_mov_b64 exec, s[40:41]
    buffer_load_dwordx4 v8, s[8:11], s21 offen offset:1024 sc1 lds
    buffer_load_dwordx4 v8, s[8:11], s21 offen offset:2048 sc1 lds
    s_mov_b64 exec, s[42:43]
    buffer_load_dwordx4 v8, s[8:11], s21 offen offset:3072 sc1 lds
    s_mov_b64 exec, -1
    buffer_load_dwordx4 v8, s[8:11], s21 offen sc1 lds
    s_add_u32 s21, s21, 3328
    s_add_u32 m0, s23, 26752
    s_mov_b64 exec, s[40:41]
    buffer_load_dwordx4 v8, s[8:11], s21 offen offset:1024 sc1 lds
    buffer_load_dwordx4 v8, s[8:11], s21 offen offset:2048 sc1 lds
    s_mov_b64 exec, s[42:43]
    buffer_load_dwordx4 v8, s[8:11], s21 offen offset:3072 sc1 lds
    s_mov_b64 exec, -1
    buffer_load_dwordx4 v8, s[8:11], s21 offen sc1 lds
    s_add_u32 s21, s21, 3328
    s_barrier
    s_add_u32 m0, s23, 40128
    s_mov_b64 exec, s[40:41]
    buffer_load_dwordx4 v8, s[8:11], s21 offen offset:1024 sc1 lds
    buffer_load_dwordx4 v8, s[8:11], s21 offen offset:2048 sc1 lds
    s_mov_b64 exec, s[42:43]
    buffer_load_dwordx4 v8, s[8:11], s21 offen offset:3072 sc1 lds
    s_mov_b64 exec, -1
    buffer_load_dwordx4 v8, s[8:11], s21 offen sc1 lds
    s_add_u32 s21, s21, 3328
    s_add_u32 m0, s23, 53504
    s_mov_b64 exec, s[40:41]
    buffer_load_dwordx4 v8, s[8:11], s21 offen offset:1024 sc1 lds
    buffer_load_dwordx4 v8, s[8:11], s21 offen offset:2048 sc1 lds
    s_mov_b64 exec, s[42:43]
    buffer_load_dwordx4 v8, s[8:11], s21 offen offset:3072 sc1 lds
    s_mov_b64 exec, -1
    buffer_load_dwordx4 v8, s[8:11], s21 offen sc1 lds
    s_add_u32 s21, s21, 3328
L_ld_fin:
    s_mov_b32 exec_hi, 0x1ffff
    ds_write_b128 v10, v[12:15] offset:0
    ds_write_b128 v10, v[12:15] offset:13376
    ds_write_b128 v10, v[12:15] offset:26752
    ds_write_b128 v10, v[12:15] offset:40128
    s_mov_b32 exec_hi, -1
    s_mov_b32 s18, 1
    s_waitcnt lgkmcnt(0)
    s_branch L_join
L_ld_idle0:
    s_mov_b32 s18, 0
    s_waitcnt vmcnt(12)
    s_barrier
    s_waitcnt vmcnt(6)
    s_barrier
    s_waitcnt vmcnt(0)
    s_barrier
    s_barrier
    s_branch L_join
L_comp:
    v_and_b32 v4, 7, v2
    v_xor_b32 v4, v4, v3
    v_lshlrev_b32 v4, 4, v4
    v_lshl_add_u32 v4, v2, 7, v4
    s_lshl_b32 s3, s12, 12
    v_add_u32 v8, s3, v4
    v_xor_b32 v9, 64, v8
    s_lshl_b32 s3, s14, 11
    v_add_u32 v10, s3, v4
    v_xor_b32 v11, 64, v10
    v_lshrrev_b32 v4, 1, v3
    v_mul_u32_u24 v4, 2560, v4
    v_and_b32 v5, 1, v3
    v_lshl_add_u32 v4, v5, 7, v4
    v_lshl_add_u32 v4, v2, 3, v4
    v_add_u32 v12, 16384, v4
    v_lshrrev_b32 v4, 2, v2
    v_lshl_add_u32 v4, v3, 3, v4
    v_mul_u32_u24 v4, 40, v4
    v_and_b32 v5, 3, v2
    v_lshl_add_u32 v4, v5, 3, v4
    s_lshr_b32 s3, s12, 1
    s_mul_i32 s3, s3, 3072
    s_and_b32 s4, s12, 1
    s_lshl_b32 s4, s4, 5
    s_add_u32 s3, s3, s4
    s_add_u32 s3, s3, 26624
    v_add_u32 v13, s3, v4
    s_mov_b32 s35, 0
    s_mov_b32 s46, 0
    s_mul_i32 s4, s12, 1280
    s_add_u32 s4, s4, 131072
    v_and_b32 v6, 3, v2
    v_bfe_u32 v7, v2, 2, 1
    v_lshl_add_u32 v6, v7, 3, v6
    v_bfe_u32 v7, v2, 3, 1
    v_lshl_add_u32 v6, v7, 2, v6
    v_add_u32 v4, 0, v3
    v_mul_u32_u24 v5, 205, v4
    v_lshrrev_b32 v5, 10, v5
    v_mul_u32_u24 v7, 5, v5
    v_sub_u32 v4, v4, v7
    v_mul_u32_u24 v5, 5120, v5
    v_lshrrev_b32 v7, 1, v4
    v_lshl_add_u32 v7, v7, 5, v6
    v_lshlrev_b32 v7, 4, v7
    v_and_b32 v124, 1, v4
    v_lshl_add_u32 v7, v124, 3, v7
    v_lshlrev_b32 v124, 3, v6
    v_add_u32 v124, 1024, v124
    v_cmp_eq_u32 vcc, 4, v4
    v_mov_b32 v125, 256
    v_mov_b32 v126, 128
    v_cndmask_b32 v7, v7, v124, vcc
    v_cndmask_b32 v125, v125, v126, vcc
    v_add3_u32 v14, v5, v7, s4
    v_add_u32 v15, v14, v125
    v_add_u32 v4, 4, v3
    v_mul_u32_u24 v5, 205, v4
    v_lshrrev_b32 v5, 10, v5
    v_mul_u32_u24 v7, 5, v5
    v_sub_u32 v4, v4, v7
    v_mul_u32_u24 v5, 5120, v5
    v_lshrrev_b32 v7, 1, v4
    v_lshl_add_u32 v7, v7, 5, v6
    v_lshlrev_b32 v7, 4, v7
    v_and_b32 v124, 1, v4
    v_lshl_add_u32 v7, v124, 3, v7
    v_lshlrev_b32 v124, 3, v6
    v_add_u32 v124, 1024, v124
    v_cmp_eq_u32 vcc, 4, v4
    v_mov_b32 v125, 256
    v_mov_b32 v126, 128
    v_cndmask_b32 v7, v7, v124, vcc
    v_cndmask_b32 v125, v125, v126, vcc
    v_add3_u32 v16, v5, v7, s4
    v_add_u32 v17, v16, v125
    v_add_u32 v4, 8, v3
    v_mul_u32_u24 v5, 205, v4
    v_lshrrev_b32 v5, 10, v5
    v_mul_u32_u24 v7, 5, v5
    v_sub_u32 v4, v4, v7
    v_mul_u32_u24 v5, 5120, v5
    v_lshrrev_b32 v7, 1, v4
    v_lshl_add_u32 v7, v7, 5, v6
    v_lshlrev_b32 v7, 4, v7
    v_and_b32 v124, 1, v4
    v_lshl_add_u32 v7, v124, 3, v7
    v_lshlrev_b32 v124, 3, v6
    v_add_u32 v124, 1024, v124
    v_cmp_eq_u32 vcc, 4, v4
    v_mov_b32 v125, 256
    v_mov_b32 v126, 128
    v_cndmask_b32 v7, v7, v124, vcc
    v_cndmask_b32 v125, v125, v126, vcc
    v_add3_u32 v18, v5, v7, s4
    v_add_u32 v19, v18, v125
    v_add_u32 v4, 12, v3
    v_mul_u32_u24 v5, 205, v4
    v_lshrrev_b32 v5, 10, v5
    v_mul_u32_u24 v7, 5, v5
    v_sub_u32 v4, v4, v7
    v_mul_u32_u24 v5, 5120, v5
    v_lshrrev_b32 v7, 1, v4
    v_lshl_add_u32 v7, v7, 5, v6
    v_lshlrev_b32 v7, 4, v7
    v_and_b32 v124, 1, v4
    v_lshl_add_u32 v7, v124, 3, v7
    v_lshlrev_b32 v124, 3, v6
    v_add_u32 v124, 1024, v124
    v_cmp_eq_u32 vcc, 4, v4
    v_mov_b32 v125, 256
    v_mov_b32 v126, 128
    v_cndmask_b32 v7, v7, v124, vcc
    v_cndmask_b32 v125, v125, v126, vcc
    v_add3_u32 v20, v5, v7, s4
    v_add_u32 v21, v20, v125
    v_add_u32 v4, 16, v3
    v_mul_u32_u24 v5, 205, v4
    v_lshrrev_b32 v5, 10, v5
    v_mul_u32_u24 v7, 5, v5
    v_sub_u32 v4, v4, v7
    v_mul_u32_u24 v5, 5120, v5
    v_lshrrev_b32 v7, 1, v4
    v_lshl_add_u32 v7, v7, 5, v6
    v_lshlrev_b32 v7, 4, v7
    v_and_b32 v124, 1, v4
    v_lshl_add_u32 v7, v124, 3, v7
    v_lshlrev_b32 v124, 3, v6
    v_add_u32 v124, 1024, v124
    v_cmp_eq_u32 vcc, 4, v4
    v_mov_b32 v125, 256
    v_mov_b32 v126, 128
    v_cndmask_b32 v7, v7, v124, vcc
    v_cndmask_b32 v125, v125, v126, vcc
    v_add3_u32 v22, v5, v7, s4
    v_add_u32 v23, v22, v125
    v_lshrrev_b32 v6, 1, v3
    v_mul_u32_u24 v6, 320, v6
    v_and_b32 v7, 1, v3
    v_lshl_add_u32 v6, v7, 3, v6
    v_add_u32 v4, 0, v2
    v_mul_u32_u24 v5, 205, v4
    v_lshrrev_b32 v5, 12, v5
    v_mul_u32_u24 v7, 20, v5
    v_sub_u32 v4, v4, v7
    v_mul_u32_u24 v5, 5120, v5
    v_lshl_add_u32 v4, v4, 4, v6
    v_add3_u32 v24, v4, v5, s4
    v_add_u32 v4, 16, v2
    v_mul_u32_u24 v5, 205, v4
    v_lshrrev_b32 v5, 12, v5
    v_mul_u32_u24 v7, 20, v5
    v_sub_u32 v4, v4, v7
    v_mul_u32_u24 v5, 5120, v5
    v_lshl_add_u32 v4, v4, 4, v6
    v_add3_u32 v25, v4, v5, s4
    v_add_u32 v4, 32, v2
    v_mul_u32_u24 v5, 205, v4
    v_lshrrev_b32 v5, 12, v5
    v_mul_u32_u24 v7, 20, v5
    v_sub_u32 v4, v4, v7
    v_mul_u32_u24 v5, 5120, v5
    v_lshl_add_u32 v4, v4, 4, v6
    v_add3_u32 v26, v4, v5, s4
    v_add_u32 v4, 48, v2
    v_mul_u32_u24 v5, 205, v4
    v_lshrrev_b32 v5, 12, v5
    v_mul_u32_u24 v7, 20, v5
    v_sub_u32 v4, v4, v7
    v_mul_u32_u24 v5, 5120, v5
    v_lshl_add_u32 v4, v4, 4, v6
    v_add3_u32 v27, v4, v5, s4
    v_add_u32 v4, 64, v2
    v_mul_u32_u24 v5, 205, v4
    v_lshrrev_b32 v5, 12, v5
    v_mul_u32_u24 v7, 20, v5
    v_sub_u32 v4, v4, v7
    v_mul_u32_u24 v5, 5120, v5
    v_lshl_add_u32 v4, v4, 4, v6
    v_add3_u32 v28, v4, v5, s4
    v_mov_b32 v32, 0
    v_mov_b32 v33, 0
    v_mov_b32 v34, 0
    v_mov_b32 v35, 0
    v_mov_b32 v36, 0
    v_mov_b32 v37, 0
    v_mov_b32 v38, 0
    v_mov_b32 v39, 0
    v_mov_b32 v40, 0
    v_mov_b32 v41, 0
    v_mov_b32 v42, 0
    v_mov_b32 v43, 0
    v_mov_b32 v44, 0
    v_mov_b32 v45, 0
    v_mov_b32 v46, 0
    v_mov_b32 v47, 0
    v_mov_b32 v48, 0
    v_mov_b32 v49, 0
    v_mov_b32 v50, 0
    v_mov_b32 v51, 0
    v_mov_b32 v52, 0
    v_mov_b32 v53, 0
    v_mov_b32 v54, 0
    v_mov_b32 v55, 0
    v_mov_b32 v56, 0
    v_mov_b32 v57, 0
    v_mov_b32 v58, 0
    v_mov_b32 v59, 0
    v_mov_b32 v60, 0
    v_mov_b32 v61, 0
    v_mov_b32 v62, 0
    v_mov_b32 v63, 0
    v_mov_b32 v64, 0
    v_mov_b32 v65, 0
    v_mov_b32 v66, 0
    v_mov_b32 v67, 0
    v_mov_b32 v68, 0
    v_mov_b32 v69, 0
    v_mov_b32 v70, 0
    v_mov_b32 v71, 0
    v_mov_b32 v72, 0
    v_mov_b32 v73, 0
    v_mov_b32 v74, 0
    v_mov_b32 v75, 0
L_round:
    s_mov_b32 s34, 0
    s_add_u32 s3, s13, s36
    s_lshr_b32 s4, s32, 3
    s_add_u32 s4, s4, 1
    s_mul_i32 s5, s13, 3
    s_cmp_eq_u32 s3, 1
    s_cselect_b32 s37, s5, s4
    v_add_u32 v8, s46, v8
    v_add_u32 v9, s46, v9
    v_add_u32 v12, s46, v12
    s_waitcnt lgkmcnt(0)
    s_barrier
    s_cmp_lg_u32 s3, 2
    s_cbranch_scc1 L_rnd_noq
    s_mul_i32 s3, s12, 2560
    s_add_u32 s3, s3, 131072
    v_lshlrev_b32 v4, 4, v1
    v_add_u32 v4, s3, v4
    v_and_b32 v5, 31, v1
    v_lshlrev_b32 v5, 3, v5
    v_add_u32 v5, s3, v5
    ds_read_b128 v[148:151], v4
    ds_read_b64 v[156:157], v5 offset:1024
    ds_read_b128 v[152:155], v4 offset:1280
    ds_read_b64 v[158:159], v5 offset:2304
    s_waitcnt lgkmcnt(0)
L_rnd_noq:
    ds_read_b128 v[76:79], v8 offset:0
    ds_read_b128 v[80:83], v8 offset:2048
    ds_read_b64_tr_b16 v[100:101], v12 offset:0
    ds_read_b64_tr_b16 v[102:103], v12 offset:1280
    ds_read_b64_tr_b16 v[104:105], v12 offset:256
    ds_read_b64_tr_b16 v[106:107], v12 offset:1536
    ds_read_b64_tr_b16 v[108:109], v12 offset:512
    ds_read_b64_tr_b16 v[110:111], v12 offset:1792
    ds_read_b64_tr_b16 v[112:113], v12 offset:768
    ds_read_b64_tr_b16 v[114:115], v12 offset:2048
    ds_read_b64_tr_b16 v[116:117], v12 offset:1024
    ds_read_b64_tr_b16 v[118:119], v12 offset:2304
    s_cmp_eq_u32 s37, 2
    s_waitcnt lgkmcnt(0)
    s_cbranch_scc1 L_g_N_mid
    s_cmp_eq_u32 s37, 3
    s_cbranch_scc0 L_g_T_mid
    ds_read_b128 v[84:87], v10
    ds_read_b64_tr_b16 v[120:121], v13 offset:0
    ds_read_b64_tr_b16 v[122:123], v13 offset:160
    s_cmp_lt_u32 s12, 2
    s_waitcnt lgkmcnt(0)
    s_cbranch_scc1 L_g_ET_mid
    s_branch L_g_EN_mid
L_g_ET:
    s_waitcnt lgkmcnt(12)
    v_mfma_f32_16x16x32_bf16 v[32:35], v[100:103], v[88:91], v[32:35]
    s_waitcnt lgkmcnt(11)
    v_mfma_f32_16x16x32_bf16 v[52:55], v[100:103], v[92:95], v[52:55]
    v_add_u32 v8, s46, v8
    v_add_u32 v9, s46, v9
    v_add_u32 v12, s46, v12
    v_add_u32 v10, s46, v10
    v_add_u32 v11, s46, v11
    v_add_u32 v13, s46, v13
    s_waitcnt lgkmcnt(0)
    s_barrier
    ds_read_b64_tr_b16 v[100:101], v12 offset:0
    ds_read_b64_tr_b16 v[102:103], v12 offset:1280
    v_mfma_f32_16x16x32_bf16 v[36:39], v[104:107], v[88:91], v[36:39]
    ds_read_b128 v[76:79], v8 offset:0
    v_mfma_f32_16x16x32_bf16 v[56:59], v[104:107], v[92:95], v[56:59]
    ds_read_b64_tr_b16 v[104:105], v12 offset:256
    ds_read_b128 v[80:83], v8 offset:2048
    v_mfma_f32_16x16x32_bf16 v[40:43], v[108:111], v[88:91], v[40:43]
    ds_read_b64_tr_b16 v[106:107], v12 offset:1536
    v_mfma_f32_16x16x32_bf16 v[60:63], v[108:111], v[92:95], v[60:63]
    ds_read_b64_tr_b16 v[108:109], v12 offset:512
    v_mfma_f32_16x16x32_bf16 v[44:47], v[112:115], v[88:91], v[44:47]
    ds_read_b64_tr_b16 v[110:111], v12 offset:1792
    ds_read_b128 v[84:87], v10
    v_mfma_f32_16x16x32_bf16 v[64:67], v[112:115], v[92:95], v[64:67]
    ds_read_b64_tr_b16 v[112:113], v12 offset:768
    v_mfma_f32_16x16x32_bf16 v[48:51], v[116:119], v[88:91], v[48:51]
    ds_read_b64_tr_b16 v[114:115], v12 offset:2048
    v_mfma_f32_16x16x32_bf16 v[68:71], v[116:119], v[92:95], v[68:71]
    ds_read_b64_tr_b16 v[116:117], v12 offset:1024
    ds_read_b64_tr_b16 v[118:119], v12 offset:2304
    v_mfma_f32_16x16x32_bf16 v[72:75], v[120:123], v[96:99], v[72:75]
    ds_read_b64_tr_b16 v[120:121], v13 offset:0
    ds_read_b64_tr_b16 v[122:123], v13 offset:160
L_g_ET_mid:
    s_waitcnt lgkmcnt(12)
    v_mfma_f32_16x16x32_bf16 v[32:35], v[100:103], v[76:79], v[32:35]
    ds_read_b128 v[88:91], v9 offset:0
    s_waitcnt lgkmcnt(11)
    v_mfma_f32_16x16x32_bf16 v[52:55], v[100:103], v[80:83], v[52:55]
    ds_read_b64_tr_b16 v[100:101], v12 offset:5120
    ds_read_b64_tr_b16 v[102:103], v12 offset:6400
    s_waitcnt lgkmcnt(12)
    v_mfma_f32_16x16x32_bf16 v[36:39], v[104:107], v[76:79], v[36:39]
    ds_read_b128 v[92:95], v9 offset:2048
    v_mfma_f32_16x16x32_bf16 v[56:59], v[104:107], v[80:83], v[56:59]
    ds_read_b64_tr_b16 v[104:105], v12 offset:5376
    s_waitcnt lgkmcnt(12)
    v_mfma_f32_16x16x32_bf16 v[40:43], v[108:111], v[76:79], v[40:43]
    ds_read_b64_tr_b16 v[106:107], v12 offset:6656
    v_mfma_f32_16x16x32_bf16 v[60:63], v[108:111], v[80:83], v[60:63]
    ds_read_b64_tr_b16 v[108:109], v12 offset:5632
    s_waitcnt lgkmcnt(11)
    v_mfma_f32_16x16x32_bf16 v[44:47], v[112:115], v[76:79], v[44:47]
    ds_read_b64_tr_b16 v[110:111], v12 offset:6912
    ds_read_b128 v[96:99], v11
    v_mfma_f32_16x16x32_bf16 v[64:67], v[112:115], v[80:83], v[64:67]
    ds_read_b64_tr_b16 v[112:113], v12 offset:5888
    s_waitcnt lgkmcnt(12)
    v_mfma_f32_16x16x32_bf16 v[48:51], v[116:119], v[76:79], v[48:51]
    ds_read_b64_tr_b16 v[114:115], v12 offset:7168
    v_mfma_f32_16x16x32_bf16 v[68:71], v[116:119], v[80:83], v[68:71]
    ds_read_b64_tr_b16 v[116:117], v12 offset:6144
    ds_read_b64_tr_b16 v[118:119], v12 offset:7424
    s_waitcnt lgkmcnt(13)
    v_mfma_f32_16x16x32_bf16 v[72:75], v[120:123], v[84:87], v[72:75]
    ds_read_b64_tr_b16 v[120:121], v13 offset:1280
    ds_read_b64_tr_b16 v[122:123], v13 offset:1440
    s_add_u32 s35, s35, 1
    s_and_b32 s35, s35, 3
    s_mov_b32 s46, 0xfffe8000
    s_cselect_b32 s46, 32768, s46
    s_add_u32 s34, s34, 1
    s_cmp_lt_u32 s34, 10
    s_cbranch_scc1 L_g_ET
    s_waitcnt lgkmcnt(12)
    v_mfma_f32_16x16x32_bf16 v[32:35], v[100:103], v[88:91], v[32:35]
    s_waitcnt lgkmcnt(11)
    v_mfma_f32_16x16x32_bf16 v[52:55], v[100:103], v[92:95], v[52:55]
    s_waitcnt lgkmcnt(9)
    v_mfma_f32_16x16x32_bf16 v[36:39], v[104:107], v[88:91], v[36:39]
    v_mfma_f32_16x16x32_bf16 v[56:59], v[104:107], v[92:95], v[56:59]
    s_waitcnt lgkmcnt(7)
    v_mfma_f32_16x16x32_bf16 v[40:43], v[108:111], v[88:91], v[40:43]
    v_mfma_f32_16x16x32_bf16 v[60:63], v[108:111], v[92:95], v[60:63]
    s_waitcnt lgkmcnt(4)
    v_mfma_f32_16x16x32_bf16 v[44:47], v[112:115], v[88:91], v[44:47]
    v_mfma_f32_16x16x32_bf16 v[64:67], v[112:115], v[92:95], v[64:67]
    s_waitcnt lgkmcnt(2)
    v_mfma_f32_16x16x32_bf16 v[48:51], v[116:119], v[88:91], v[48:51]
    v_mfma_f32_16x16x32_bf16 v[68:71], v[116:119], v[92:95], v[68:71]
    s_waitcnt lgkmcnt(0)
    v_mfma_f32_16x16x32_bf16 v[72:75], v[120:123], v[96:99], v[72:75]
    s_lshl_b32 s3, s12, 9
    s_add_u32 s3, s3, 151552
    v_lshlrev_b32 v4, 3, v1
    v_add_u32 v4, s3, v4
    s_nop 7
    v_cvt_pk_bf16_f32 v132, v72, v73
    v_cvt_pk_bf16_f32 v133, v74, v75
    ds_write_b64 v4, v[132:133]
    s_branch L_epi
L_g_EN:
    s_waitcnt lgkmcnt(12)
    v_mfma_f32_16x16x32_bf16 v[32:35], v[100:103], v[88:91], v[32:35]
    s_waitcnt lgkmcnt(11)
    v_mfma_f32_16x16x32_bf16 v[52:55], v[100:103], v[92:95], v[52:55]
    v_add_u32 v8, s46, v8
    v_add_u32 v9, s46, v9
    v_add_u32 v12, s46, v12
    v_add_u32 v10, s46, v10
    v_add_u32 v11, s46, v11
    v_add_u32 v13, s46, v13
    s_waitcnt lgkmcnt(0)
    s_barrier
    ds_read_b64_tr_b16 v[100:101], v12 offset:0
    ds_read_b64_tr_b16 v[102:103], v12 offset:1280
    v_mfma_f32_16x16x32_bf16 v[36:39], v[104:107], v[88:91], v[36:39]
    ds_read_b128 v[76:79], v8 offset:0
    v_mfma_f32_16x16x32_bf16 v[56:59], v[104:107], v[92:95], v[56:59]
    ds_read_b64_tr_b16 v[104:105], v12 offset:256
    ds_read_b128 v[80:83], v8 offset:2048
    v_mfma_f32_16x16x32_bf16 v[40:43], v[108:111], v[88:91], v[40:43]
    ds_read_b64_tr_b16 v[106:107], v12 offset:1536
    v_mfma_f32_16x16x32_bf16 v[60:63], v[108:111], v[92:95], v[60:63]
    ds_read_b64_tr_b16 v[108:109], v12 offset:512
    v_mfma_f32_16x16x32_bf16 v[44:47], v[112:115], v[88:91], v[44:47]
    ds_read_b64_tr_b16 v[110:111], v12 offset:1792
    ds_read_b128 v[84:87], v10
    v_mfma_f32_16x16x32_bf16 v[64:67], v[112:115], v[92:95], v[64:67]
    ds_read_b64_tr_b16 v[112:113], v12 offset:768
    v_mfma_f32_16x16x32_bf16 v[48:51], v[116:119], v[88:91], v[48:51]
    ds_read_b64_tr_b16 v[114:115], v12 offset:2048
    v_mfma_f32_16x16x32_bf16 v[68:71], v[116:119], v[92:95], v[68:71]
    ds_read_b64_tr_b16 v[116:117], v12 offset:1024
    ds_read_b64_tr_b16 v[118:119], v12 offset:2304
    v_mfma_f32_16x16x32_bf16 v[72:75], v[96:99], v[120:123], v[72:75]
    ds_read_b64_tr_b16 v[120:121], v13 offset:0
    ds_read_b64_tr_b16 v[122:123], v13 offset:160
L_g_EN_mid:
    s_waitcnt lgkmcnt(12)
    v_mfma_f32_16x16x32_bf16 v[32:35], v[100:103], v[76:79], v[32:35]
    ds_read_b128 v[88:91], v9 offset:0
    s_waitcnt lgkmcnt(11)
    v_mfma_f32_16x16x32_bf16 v[52:55], v[100:103], v[80:83], v[52:55]
    ds_read_b64_tr_b16 v[100:101], v12 offset:5120
    ds_read_b64_tr_b16 v[102:103], v12 offset:6400
    s_waitcnt lgkmcnt(12)
    v_mfma_f32_16x16x32_bf16 v[36:39], v[104:107], v[76:79], v[36:39]
    ds_read_b128 v[92:95], v9 offset:2048
    v_mfma_f32_16x16x32_bf16 v[56:59], v[104:107], v[80:83], v[56:59]
    ds_read_b64_tr_b16 v[104:105], v12 offset:5376
    s_waitcnt lgkmcnt(12)
    v_mfma_f32_16x16x32_bf16 v[40:43], v[108:111], v[76:79], v[40:43]
    ds_read_b64_tr_b16 v[106:107], v12 offset:6656
    v_mfma_f32_16x16x32_bf16 v[60:63], v[108:111], v[80:83], v[60:63]
    ds_read_b64_tr_b16 v[108:109], v12 offset:5632
    s_waitcnt lgkmcnt(11)
    v_mfma_f32_16x16x32_bf16 v[44:47], v[112:115], v[76:79], v[44:47]
    ds_read_b64_tr_b16 v[110:111], v12 offset:6912
    ds_read_b128 v[96:99], v11
    v_mfma_f32_16x16x32_bf16 v[64:67], v[112:115], v[80:83], v[64:67]
    ds_read_b64_tr_b16 v[112:113], v12 offset:5888
    s_waitcnt lgkmcnt(12)
    v_mfma_f32_16x16x32_bf16 v[48:51], v[116:119], v[76:79], v[48:51]
    ds_read_b64_tr_b16 v[114:115], v12 offset:7168
    v_mfma_f32_16x16x32_bf16 v[68:71], v[116:119], v[80:83], v[68:71]
    ds_read_b64_tr_b16 v[116:117], v12 offset:6144
    ds_read_b64_tr_b16 v[118:119], v12 offset:7424
    s_waitcnt lgkmcnt(13)
    v_mfma_f32_16x16x32_bf16 v[72:75], v[84:87], v[120:123], v[72:75]
    ds_read_b64_tr_b16 v[120:121], v13 offset:1280
    ds_read_b64_tr_b16 v[122:123], v13 offset:1440
    s_add_u32 s35, s35, 1
    s_and_b32 s35, s35, 3
    s_mov_b32 s46, 0xfffe8000
    s_cselect_b32 s46, 32768, s46
    s_add_u32 s34, s34, 1
    s_cmp_lt_u32 s34, 10
    s_cbranch_scc1 L_g_EN
    s_waitcnt lgkmcnt(12)
    v_mfma_f32_16x16x32_bf16 v[32:35], v[100:103], v[88:91], v[32:35]
    s_waitcnt lgkmcnt(11)
    v_mfma_f32_16x16x32_bf16 v[52:55], v[100:103], v[92:95], v[52:55]
    s_waitcnt lgkmcnt(9)
    v_mfma_f32_16x16x32_bf16 v[36:39], v[104:107], v[88:91], v[36:39]
    v_mfma_f32_16x16x32_bf16 v[56:59], v[104:107], v[92:95], v[56:59]
    s_waitcnt lgkmcnt(7)
    v_mfma_f32_16x16x32_bf16 v[40:43], v[108:111], v[88:91], v[40:43]
    v_mfma_f32_16x16x32_bf16 v[60:63], v[108:111], v[92:95], v[60:63]
    s_waitcnt lgkmcnt(4)
    v_mfma_f32_16x16x32_bf16 v[44:47], v[112:115], v[88:91], v[44:47]
    v_mfma_f32_16x16x32_bf16 v[64:67], v[112:115], v[92:95], v[64:67]
    s_waitcnt lgkmcnt(2)
    v_mfma_f32_16x16x32_bf16 v[48:51], v[116:119], v[88:91], v[48:51]
    v_mfma_f32_16x16x32_bf16 v[68:71], v[116:119], v[92:95], v[68:71]
    s_waitcnt lgkmcnt(0)
    v_mfma_f32_16x16x32_bf16 v[72:75], v[96:99], v[120:123], v[72:75]
    s_lshl_b32 s3, s12, 9
    s_add_u32 s3, s3, 151552
    v_lshlrev_b32 v4, 3, v1
    v_add_u32 v4, s3, v4
    s_nop 7
    v_cvt_pk_bf16_f32 v132, v72, v73
    v_cvt_pk_bf16_f32 v133, v74, v75
    ds_write_b64 v4, v[132:133]
    s_branch L_epi
L_g_N:
    s_waitcnt lgkmcnt(9)
    v_mfma_f32_16x16x32_bf16 v[32:35], v[88:91], v[100:103], v[32:35]
    s_waitcnt lgkmcnt(8)
    v_mfma_f32_16x16x32_bf16 v[52:55], v[92:95], v[100:103], v[52:55]
    v_add_u32 v8, s46, v8
    v_add_u32 v9, s46, v9
    v_add_u32 v12, s46, v12
    s_waitcnt lgkmcnt(0)
    s_barrier
    ds_read_b64_tr_b16 v[100:101], v12 offset:0
    ds_read_b64_tr_b16 v[102:103], v12 offset:1280
    v_mfma_f32_16x16x32_bf16 v[36:39], v[88:91], v[104:107], v[36:39]
    ds_read_b128 v[76:79], v8 offset:0
    v_mfma_f32_16x16x32_bf16 v[56:59], v[92:95], v[104:107], v[56:59]
    ds_read_b64_tr_b16 v[104:105], v12 offset:256
    ds_read_b128 v[80:83], v8 offset:2048
    v_mfma_f32_16x16x32_bf16 v[40:43], v[88:91], v[108:111], v[40:43]
    ds_read_b64_tr_b16 v[106:107], v12 offset:1536
    v_mfma_f32_16x16x32_bf16 v[60:63], v[92:95], v[108:111], v[60:63]
    ds_read_b64_tr_b16 v[108:109], v12 offset:512
    v_mfma_f32_16x16x32_bf16 v[44:47], v[88:91], v[112:115], v[44:47]
    ds_read_b64_tr_b16 v[110:111], v12 offset:1792
    v_mfma_f32_16x16x32_bf16 v[64:67], v[92:95], v[112:115], v[64:67]
    ds_read_b64_tr_b16 v[112:113], v12 offset:768
    v_mfma_f32_16x16x32_bf16 v[48:51], v[88:91], v[116:119], v[48:51]
    ds_read_b64_tr_b16 v[114:115], v12 offset:2048
    v_mfma_f32_16x16x32_bf16 v[68:71], v[92:95], v[116:119], v[68:71]
    ds_read_b64_tr_b16 v[116:117], v12 offset:1024
    ds_read_b64_tr_b16 v[118:119], v12 offset:2304
L_g_N_mid:
    s_waitcnt lgkmcnt(9)
    v_mfma_f32_16x16x32_bf16 v[32:35], v[76:79], v[100:103], v[32:35]
    ds_read_b128 v[88:91], v9 offset:0
    s_waitcnt lgkmcnt(8)
    v_mfma_f32_16x16x32_bf16 v[52:55], v[80:83], v[100:103], v[52:55]
    ds_read_b64_tr_b16 v[100:101], v12 offset:5120
    ds_read_b64_tr_b16 v[102:103], v12 offset:6400
    s_waitcnt lgkmcnt(9)
    v_mfma_f32_16x16x32_bf16 v[36:39], v[76:79], v[104:107], v[36:39]
    ds_read_b128 v[92:95], v9 offset:2048
    v_mfma_f32_16x16x32_bf16 v[56:59], v[80:83], v[104:107], v[56:59]
    ds_read_b64_tr_b16 v[104:105], v12 offset:5376
    s_waitcnt lgkmcnt(9)
    v_mfma_f32_16x16x32_bf16 v[40:43], v[76:79], v[108:111], v[40:43]
    ds_read_b64_tr_b16 v[106:107], v12 offset:6656
    v_mfma_f32_16x16x32_bf16 v[60:63], v[80:83], v[108:111], v[60:63]
    ds_read_b64_tr_b16 v[108:109], v12 offset:5632
    s_waitcnt lgkmcnt(9)
    v_mfma_f32_16x16x32_bf16 v[44:47], v[76:79], v[112:115], v[44:47]
    ds_read_b64_tr_b16 v[110:111], v12 offset:6912
    v_mfma_f32_16x16x32_bf16 v[64:67], v[80:83], v[112:115], v[64:67]
    ds_read_b64_tr_b16 v[112:113], v12 offset:5888
    s_waitcnt lgkmcnt(9)
    v_mfma_f32_16x16x32_bf16 v[48:51], v[76:79], v[116:119], v[48:51]
    ds_read_b64_tr_b16 v[114:115], v12 offset:7168
    v_mfma_f32_16x16x32_bf16 v[68:71], v[80:83], v[116:119], v[68:71]
    ds_read_b64_tr_b16 v[116:117], v12 offset:6144
    ds_read_b64_tr_b16 v[118:119], v12 offset:7424
    s_add_u32 s35, s35, 1
    s_and_b32 s35, s35, 3
    s_mov_b32 s46, 0xfffe8000
    s_cselect_b32 s46, 32768, s46
    s_add_u32 s34, s34, 1
    s_cmp_lt_u32 s34, 10
    s_cbranch_scc1 L_g_N
    s_waitcnt lgkmcnt(9)
    v_mfma_f32_16x16x32_bf16 v[32:35], v[88:91], v[100:103], v[32:35]
    s_waitcnt lgkmcnt(8)
    v_mfma_f32_16x16x32_bf16 v[52:55], v[92:95], v[100:103], v[52:55]
    s_waitcnt lgkmcnt(6)
    v_mfma_f32_16x16x32_bf16 v[36:39], v[88:91], v[104:107], v[36:39]
    v_mfma_f32_16x16x32_bf16 v[56:59], v[92:95], v[104:107], v[56:59]
    s_waitcnt lgkmcnt(4)
    v_mfma_f32_16x16x32_bf16 v[40:43], v[88:91], v[108:111], v[40:43]
    v_mfma_f32_16x16x32_bf16 v[60:63], v[92:95], v[108:111], v[60:63]
    s_waitcnt lgkmcnt(2)
    v_mfma_f32_16x16x32_bf16 v[44:47], v[88:91], v[112:115], v[44:47]
    v_mfma_f32_16x16x32_bf16 v[64:67], v[92:95], v[112:115], v[64:67]
    s_waitcnt lgkmcnt(0)
    v_mfma_f32_16x16x32_bf16 v[48:51], v[88:91], v[116:119], v[48:51]
    v_mfma_f32_16x16x32_bf16 v[68:71], v[92:95], v[116:119], v[68:71]
    s_nop 3
    v_cvt_pk_bf16_f32 v124, v32, v33
    v_cvt_pk_bf16_f32 v125, v34, v35
    ds_write_b64 v24, v[124:125] offset:0
    v_mov_b32 v32, 0
    v_mov_b32 v33, 0
    v_mov_b32 v34, 0
    v_mov_b32 v35, 0
    v_cvt_pk_bf16_f32 v126, v52, v53
    v_cvt_pk_bf16_f32 v127, v54, v55
    ds_write_b64 v24, v[126:127] offset:640
    v_mov_b32 v52, 0
    v_mov_b32 v53, 0
    v_mov_b32 v54, 0
    v_mov_b32 v55, 0
    v_cvt_pk_bf16_f32 v128, v36, v37
    v_cvt_pk_bf16_f32 v129, v38, v39
    ds_write_b64 v25, v[128:129] offset:0
    v_mov_b32 v36, 0
    v_mov_b32 v37, 0
    v_mov_b32 v38, 0
    v_mov_b32 v39, 0
    v_cvt_pk_bf16_f32 v130, v56, v57
    v_cvt_pk_bf16_f32 v131, v58, v59
    ds_write_b64 v25, v[130:131] offset:640
    v_mov_b32 v56, 0
    v_mov_b32 v57, 0
    v_mov_b32 v58, 0
    v_mov_b32 v59, 0
    v_cvt_pk_bf16_f32 v124, v40, v41
    v_cvt_pk_bf16_f32 v125, v42, v43
    ds_write_b64 v26, v[124:125] offset:0
    v_mov_b32 v40, 0
    v_mov_b32 v41, 0
    v_mov_b32 v42, 0
    v_mov_b32 v43, 0
    v_cvt_pk_bf16_f32 v126, v60, v61
    v_cvt_pk_bf16_f32 v127, v62, v63
    ds_write_b64 v26, v[126:127] offset:640
    v_mov_b32 v60, 0
    v_mov_b32 v61, 0
    v_mov_b32 v62, 0
    v_mov_b32 v63, 0
    v_cvt_pk_bf16_f32 v128, v44, v45
    v_cvt_pk_bf16_f32 v129, v46, v47
    ds_write_b64 v27, v[128:129] offset:0
    v_mov_b32 v44, 0
    v_mov_b32 v45, 0
    v_mov_b32 v46, 0
    v_mov_b32 v47, 0
    v_cvt_pk_bf16_f32 v130, v64, v65
    v_cvt_pk_bf16_f32 v131, v66, v67
    ds_write_b64 v27, v[130:131] offset:640
    v_mov_b32 v64, 0
    v_mov_b32 v65, 0
    v_mov_b32 v66, 0
    v_mov_b32 v67, 0
    v_cvt_pk_bf16_f32 v124, v48, v49
    v_cvt_pk_bf16_f32 v125, v50, v51
    ds_write_b64 v28, v[124:125] offset:0
    v_mov_b32 v48, 0
    v_mov_b32 v49, 0
    v_mov_b32 v50, 0
    v_mov_b32 v51, 0
    v_cvt_pk_bf16_f32 v126, v68, v69
    v_cvt_pk_bf16_f32 v127, v70, v71
    ds_write_b64 v28, v[126:127] offset:640
    v_mov_b32 v68, 0
    v_mov_b32 v69, 0
    v_mov_b32 v70, 0
    v_mov_b32 v71, 0
    s_branch L_epid
L_g_T:
    s_waitcnt lgkmcnt(9)
    v_mfma_f32_16x16x32_bf16 v[32:35], v[100:103], v[88:91], v[32:35]
    s_waitcnt lgkmcnt(8)
    v_mfma_f32_16x16x32_bf16 v[52:55], v[100:103], v[92:95], v[52:55]
    v_add_u32 v8, s46, v8
    v_add_u32 v9, s46, v9
    v_add_u32 v12, s46, v12
    s_waitcnt lgkmcnt(0)
    s_barrier
    ds_read_b64_tr_b16 v[100:101], v12 offset:0
    ds_read_b64_tr_b16 v[102:103], v12 offset:1280
    v_mfma_f32_16x16x32_bf16 v[36:39], v[104:107], v[88:91], v[36:39]
    ds_read_b128 v[76:79], v8 offset:0
    v_mfma_f32_16x16x32_bf16 v[56:59], v[104:107], v[92:95], v[56:59]
    ds_read_b64_tr_b16 v[104:105], v12 offset:256
    ds_read_b128 v[80:83], v8 offset:2048
    v_mfma_f32_16x16x32_bf16 v[40:43], v[108:111], v[88:91], v[40:43]
    ds_read_b64_tr_b16 v[106:107], v12 offset:1536
    v_mfma_f32_16x16x32_bf16 v[60:63], v[108:111], v[92:95], v[60:63]
    ds_read_b64_tr_b16 v[108:109], v12 offset:512
    v_mfma_f32_16x16x32_bf16 v[44:47], v[112:115], v[88:91], v[44:47]
    ds_read_b64_tr_b16 v[110:111], v12 offset:1792
    v_mfma_f32_16x16x32_bf16 v[64:67], v[112:115], v[92:95], v[64:67]
    ds_read_b64_tr_b16 v[112:113], v12 offset:768
    v_mfma_f32_16x16x32_bf16 v[48:51], v[116:119], v[88:91], v[48:51]
    ds_read_b64_tr_b16 v[114:115], v12 offset:2048
    v_mfma_f32_16x16x32_bf16 v[68:71], v[116:119], v[92:95], v[68:71]
    ds_read_b64_tr_b16 v[116:117], v12 offset:1024
    ds_read_b64_tr_b16 v[118:119], v12 offset:2304
L_g_T_mid:
    s_waitcnt lgkmcnt(9)
    v_mfma_f32_16x16x32_bf16 v[32:35], v[100:103], v[76:79], v[32:35]
    ds_read_b128 v[88:91], v9 offset:0
    s_waitcnt lgkmcnt(8)
    v_mfma_f32_16x16x32_bf16 v[52:55], v[100:103], v[80:83], v[52:55]
    ds_read_b64_tr_b16 v[100:101], v12 offset:5120
    ds_read_b64_tr_b16 v[102:103], v12 offset:6400
    s_waitcnt lgkmcnt(9)
    v_mfma_f32_16x16x32_bf16 v[36:39], v[104:107], v[76:79], v[36:39]
    ds_read_b128 v[92:95], v9 offset:2048
    v_mfma_f32_16x16x32_bf16 v[56:59], v[104:107], v[80:83], v[56:59]
    ds_read_b64_tr_b16 v[104:105], v12 offset:5376
    s_waitcnt lgkmcnt(9)
    v_mfma_f32_16x16x32_bf16 v[40:43], v[108:111], v[76:79], v[40:43]
    ds_read_b64_tr_b16 v[106:107], v12 offset:6656
    v_mfma_f32_16x16x32_bf16 v[60:63], v[108:111], v[80:83], v[60:63]
    ds_read_b64_tr_b16 v[108:109], v12 offset:5632
    s_waitcnt lgkmcnt(9)
    v_mfma_f32_16x16x32_bf16 v[44:47], v[112:115], v[76:79], v[44:47]
    ds_read_b64_tr_b16 v[110:111], v12 offset:6912
    v_mfma_f32_16x16x32_bf16 v[64:67], v[112:115], v[80:83], v[64:67]
    ds_read_b64_tr_b16 v[112:113], v12 offset:5888
    s_waitcnt lgkmcnt(9)
    v_mfma_f32_16x16x32_bf16 v[48:51], v[116:119], v[76:79], v[48:51]
    ds_read_b64_tr_b16 v[114:115], v12 offset:7168
    v_mfma_f32_16x16x32_bf16 v[68:71], v[116:119], v[80:83], v[68:71]
    ds_read_b64_tr_b16 v[116:117], v12 offset:6144
    ds_read_b64_tr_b16 v[118:119], v12 offset:7424
    s_add_u32 s35, s35, 1
    s_and_b32 s35, s35, 3
    s_mov_b32 s46, 0xfffe8000
    s_cselect_b32 s46, 32768, s46
    s_add_u32 s34, s34, 1
    s_cmp_lt_u32 s34, 10
    s_cbranch_scc1 L_g_T
    s_waitcnt lgkmcnt(9)
    v_mfma_f32_16x16x32_bf16 v[32:35], v[100:103], v[88:91], v[32:35]
    s_waitcnt lgkmcnt(8)
    v_mfma_f32_16x16x32_bf16 v[52:55], v[100:103], v[92:95], v[52:55]
    s_waitcnt lgkmcnt(6)
    v_mfma_f32_16x16x32_bf16 v[36:39], v[104:107], v[88:91], v[36:39]
    v_mfma_f32_16x16x32_bf16 v[56:59], v[104:107], v[92:95], v[56:59]
    s_waitcnt lgkmcnt(4)
    v_mfma_f32_16x16x32_bf16 v[40:43], v[108:111], v[88:91], v[40:43]
    v_mfma_f32_16x16x32_bf16 v[60:63], v[108:111], v[92:95], v[60:63]
    s_waitcnt lgkmcnt(2)
    v_mfma_f32_16x16x32_bf16 v[44:47], v[112:115], v[88:91], v[44:47]
    v_mfma_f32_16x16x32_bf16 v[64:67], v[112:115], v[92:95], v[64:67]
    s_waitcnt lgkmcnt(0)
    v_mfma_f32_16x16x32_bf16 v[48:51], v[116:119], v[88:91], v[48:51]
    v_mfma_f32_16x16x32_bf16 v[68:71], v[116:119], v[92:95], v[68:71]
L_epi:
    s_mov_b32 s6, 0x3ea52b5c
    s_cmp_eq_u32 s37, 1
    s_cselect_b32 s6, 1.0, s6
    s_mov_b32 s7, s6
    s_nop 3
    v_pk_mul_f32 v[32:33], v[32:33], s[6:7]
    v_pk_mul_f32 v[34:35], v[34:35], s[6:7]
    v_cvt_pk_bf16_f32 v124, v32, v33
    v_cvt_pk_bf16_f32 v125, v34, v35
    ds_write_b64 v14, v[124:125]
    v_mov_b32 v32, 0
    v_mov_b32 v33, 0
    v_mov_b32 v34, 0
    v_mov_b32 v35, 0
    v_pk_mul_f32 v[52:53], v[52:53], s[6:7]
    v_pk_mul_f32 v[54:55], v[54:55], s[6:7]
    v_cvt_pk_bf16_f32 v126, v52, v53
    v_cvt_pk_bf16_f32 v127, v54, v55
    ds_write_b64 v15, v[126:127]
    v_mov_b32 v52, 0
    v_mov_b32 v53, 0
    v_mov_b32 v54, 0
    v_mov_b32 v55, 0
    v_pk_mul_f32 v[36:37], v[36:37], s[6:7]
    v_pk_mul_f32 v[38:39], v[38:39], s[6:7]
    v_cvt_pk_bf16_f32 v128, v36, v37
    v_cvt_pk_bf16_f32 v129, v38, v39
    ds_write_b64 v16, v[128:129]
    v_mov_b32 v36, 0
    v_mov_b32 v37, 0
    v_mov_b32 v38, 0
    v_mov_b32 v39, 0
    v_pk_mul_f32 v[56:57], v[56:57], s[6:7]
    v_pk_mul_f32 v[58:59], v[58:59], s[6:7]
    v_cvt_pk_bf16_f32 v130, v56, v57
    v_cvt_pk_bf16_f32 v131, v58, v59
    ds_write_b64 v17, v[130:131]
    v_mov_b32 v56, 0
    v_mov_b32 v57, 0
    v_mov_b32 v58, 0
    v_mov_b32 v59, 0
    v_pk_mul_f32 v[40:41], v[40:41], s[6:7]
    v_pk_mul_f32 v[42:43], v[42:43], s[6:7]
    v_cvt_pk_bf16_f32 v124, v40, v41
    v_cvt_pk_bf16_f32 v125, v42, v43
    ds_write_b64 v18, v[124:125]
    v_mov_b32 v40, 0
    v_mov_b32 v41, 0
    v_mov_b32 v42, 0
    v_mov_b32 v43, 0
    v_pk_mul_f32 v[60:61], v[60:61], s[6:7]
    v_pk_mul_f32 v[62:63], v[62:63], s[6:7]
    v_cvt_pk_bf16_f32 v126, v60, v61
    v_cvt_pk_bf16_f32 v127, v62, v63
    ds_write_b64 v19, v[126:127]
    v_mov_b32 v60, 0
    v_mov_b32 v61, 0
    v_mov_b32 v62, 0
    v_mov_b32 v63, 0
    v_pk_mul_f32 v[44:45], v[44:45], s[6:7]
    v_pk_mul_f32 v[46:47], v[46:47], s[6:7]
    v_cvt_pk_bf16_f32 v128, v44, v45
    v_cvt_pk_bf16_f32 v129, v46, v47
    ds_write_b64 v20, v[128:129]
    v_mov_b32 v44, 0
    v_mov_b32 v45, 0
    v_mov_b32 v46, 0
    v_mov_b32 v47, 0
    v_pk_mul_f32 v[64:65], v[64:65], s[6:7]
    v_pk_mul_f32 v[66:67], v[66:67], s[6:7]
    v_cvt_pk_bf16_f32 v130, v64, v65
    v_cvt_pk_bf16_f32 v131, v66, v67
    ds_write_b64 v21, v[130:131]
    v_mov_b32 v64, 0
    v_mov_b32 v65, 0
    v_mov_b32 v66, 0
    v_mov_b32 v67, 0
    v_pk_mul_f32 v[48:49], v[48:49], s[6:7]
    v_pk_mul_f32 v[50:51], v[50:51], s[6:7]
    v_cvt_pk_bf16_f32 v124, v48, v49
    v_cvt_pk_bf16_f32 v125, v50, v51
    ds_write_b64 v22, v[124:125]
    v_mov_b32 v48, 0
    v_mov_b32 v49, 0
    v_mov_b32 v50, 0
    v_mov_b32 v51, 0
    v_pk_mul_f32 v[68:69], v[68:69], s[6:7]
    v_pk_mul_f32 v[70:71], v[70:71], s[6:7]
    v_cvt_pk_bf16_f32 v126, v68, v69
    v_cvt_pk_bf16_f32 v127, v70, v71
    ds_write_b64 v23, v[126:127]
    v_mov_b32 v68, 0
    v_mov_b32 v69, 0
    v_mov_b32 v70, 0
    v_mov_b32 v71, 0
L_epid:
    s_cmp_eq_u32 s36, 1
    s_mov_b32 s36, 1
    s_cbranch_scc0 L_round
    s_mov_b32 s18, 0
    s_waitcnt lgkmcnt(0)
    s_barrier
L_join:
    s_cmp_eq_u32 s13, 1
    s_cbranch_scc1 L_haveq
    s_mul_i32 s3, s12, 2560
    s_add_u32 s3, s3, 131072
    v_lshlrev_b32 v4, 4, v1
    v_add_u32 v4, s3, v4
    v_and_b32 v5, 31, v1
    v_lshlrev_b32 v5, 3, v5
    v_add_u32 v5, s3, v5
    ds_read_b128 v[148:151], v4
    ds_read_b64 v[156:157], v5 offset:1024
    ds_read_b128 v[152:155], v4 offset:1280
    ds_read_b64 v[158:159], v5 offset:2304
    s_waitcnt lgkmcnt(0)
L_haveq:
    s_lshl_b32 s3, s14, 2
    s_cmp_eq_u32 s13, 0
    s_cselect_b32 s3, s3, 32
    s_cselect_b32 s22, 4, 1
    s_mul_i32 s20, s3, 212992
    s_add_u32 s20, s20, 10485760
    v_lshlrev_b32 v8, 4, v1
    s_lshr_b32 s3, s12, 1
    s_cmp_eq_u32 s13, 0
    s_cselect_b32 s4, s3, 0
    s_mul_i32 s5, s4, 212992
    s_add_u32 s20, s20, s5
    s_mul_i32 s4, s4, 3344
    v_add_u32 v9, s4, v8
    v_add_u32 v10, 53504, v9
    v_and_b32 v5, 31, v1
    v_lshlrev_b32 v13, 3, v5
    v_add_u32 v4, 3072, v13
    v_mov_b32 v5, 3328
    v_cndmask_b32 v4, v4, v5, s[44:45]
    v_add_u32 v11, s4, v4
    v_add_u32 v12, 53504, v11
    s_lshl_b32 s4, s13, 5
    s_lshl_b32 s5, s14, 2
    s_add_u32 s4, s4, s5
    s_add_u32 s4, s4, s3
    s_lshl_b32 s4, s4, 6
    s_lshl_b32 s5, s15, 2
    s_add_u32 s4, s4, s5
    s_and_b32 s5, s12, 1
    s_lshl_b32 s5, s5, 1
    s_add_u32 s4, s4, s5
    s_mul_i32 s19, s4, 1280
    s_add_u32 s19, s19, 5242880
    s_mov_b32 s34, 0
    v_mov_b32 v84, 0
    v_mov_b32 v100, 0
    v_mov_b32 v85, 0
    v_mov_b32 v101, 0
    v_mov_b32 v86, 0
    v_mov_b32 v102, 0
    v_mov_b32 v87, 0
    v_mov_b32 v103, 0
    v_mov_b32 v88, 0
    v_mov_b32 v104, 0
    v_mov_b32 v89, 0
    v_mov_b32 v105, 0
    v_mov_b32 v90, 0
    v_mov_b32 v106, 0
    v_mov_b32 v91, 0
    v_mov_b32 v107, 0
    v_mov_b32 v92, 0
    v_mov_b32 v108, 0
    v_mov_b32 v93, 0
    v_mov_b32 v109, 0
    v_mov_b32 v94, 0
    v_mov_b32 v110, 0
    v_mov_b32 v95, 0
    v_mov_b32 v111, 0
    v_mov_b32 v96, 0
    v_mov_b32 v112, 0
    v_mov_b32 v97, 0
    v_mov_b32 v113, 0
    v_mov_b32 v98, 0
    v_mov_b32 v114, 0
    v_mov_b32 v99, 0
    v_mov_b32 v115, 0
    v_mov_b32 v48, 0
    v_mov_b32 v40, 0
    v_mov_b32 v49, 0
    v_mov_b32 v41, 0
    v_mov_b32 v50, 0
    v_mov_b32 v42, 0
    v_mov_b32 v51, 0
    v_mov_b32 v43, 0
    v_cndmask_b32 v156, v156, 0, s[44:45]
    v_cndmask_b32 v157, v157, 0, s[44:45]
    v_cndmask_b32 v158, v158, 0, s[44:45]
    v_cndmask_b32 v159, v159, 0, s[44:45]
    s_waitcnt vmcnt(8) lgkmcnt(0)
    s_barrier
    ds_read_b128 v[20:23], v9
    ds_read_b64 v[16:17], v11
    ds_read_b128 v[28:31], v9 offset:1024
    ds_read_b128 v[36:39], v9 offset:2048
    ds_read_b128 v[24:27], v9 offset:13376
    ds_read_b64 v[18:19], v11 offset:13376
    s_cmp_eq_u32 s18, 0
    s_cbranch_scc1 L_no56
    s_add_u32 m0, s23, 66880
    s_mov_b64 exec, s[40:41]
    buffer_load_dwordx4 v8, s[8:11], s21 offen offset:1024 sc1 lds
    buffer_load_dwordx4 v8, s[8:11], s21 offen offset:2048 sc1 lds
    s_mov_b64 exec, s[42:43]
    buffer_load_dwordx4 v8, s[8:11], s21 offen offset:3072 sc1 lds
    s_mov_b64 exec, -1
    buffer_load_dwordx4 v8, s[8:11], s21 offen sc1 lds
    s_add_u32 s21, s21, 3328
    s_add_u32 m0, s23, 80256
    s_mov_b64 exec, s[40:41]
    buffer_load_dwordx4 v8, s[8:11], s21 offen offset:1024 sc1 lds
    buffer_load_dwordx4 v8, s[8:11], s21 offen offset:2048 sc1 lds
    s_mov_b64 exec, s[42:43]
    buffer_load_dwordx4 v8, s[8:11], s21 offen offset:3072 sc1 lds
    s_mov_b64 exec, -1
    buffer_load_dwordx4 v8, s[8:11], s21 offen sc1 lds
    s_add_u32 s21, s21, 3328
L_no56:
    s_waitcnt lgkmcnt(4)
    v_mfma_f32_32x32x16_bf16 v[52:67], v[20:23], v[148:151], 0
    v_mfma_f32_32x32x8_bf16 v[52:67], v[16:17], v[156:157], v[52:67]
    v_mfma_f32_32x32x16_bf16 v[68:83], v[20:23], v[152:155], 0
    v_mfma_f32_32x32x8_bf16 v[68:83], v[16:17], v[158:159], v[68:83]
    s_nop 7
    s_nop 3
    v_max3_f32 v14, v52, v53, v54
    v_max_f32 v14, v14, v55
    v_max3_f32 v14, v14, v56, v57
    v_max3_f32 v14, v14, v58, v59
    v_max3_f32 v14, v14, v60, v61
    v_max3_f32 v14, v14, v62, v63
    v_max3_f32 v14, v14, v64, v65
    v_max3_f32 v14, v14, v66, v67
    v_mov_b32 v4, v14
    s_nop 1
    v_permlane32_swap_b32 v14, v4
    s_nop 1
    v_max_f32 v4, v14, v4
    v_sub_f32 v4, 0, v4
    v_and_b32 v5, 0xffff0000, v4
    v_sub_f32 v4, v4, v5
    v_and_b32 v6, 0xffff0000, v4
    v_sub_f32 v4, v4, v6
    s_mov_b32 s3, 0x07060302
    v_perm_b32 v5, v6, v5, s3
    v_lshrrev_b32 v4, 16, v4
    v_cndmask_b32 v156, v156, v5, s[44:45]
    v_cndmask_b32 v157, v157, v4, s[44:45]
    s_nop 1
    v_mfma_f32_32x32x16_bf16 v[52:67], v[20:23], v[148:151], 0
    v_mfma_f32_32x32x8_bf16 v[52:67], v[16:17], v[156:157], v[52:67]
    v_max3_f32 v15, v68, v69, v70
    v_max_f32 v15, v15, v71
    v_max3_f32 v15, v15, v72, v73
    v_max3_f32 v15, v15, v74, v75
    v_max3_f32 v15, v15, v76, v77
    v_max3_f32 v15, v15, v78, v79
    v_max3_f32 v15, v15, v80, v81
    v_max3_f32 v15, v15, v82, v83
    v_mov_b32 v4, v15
    s_nop 1
    v_permlane32_swap_b32 v15, v4
    s_nop 1
    v_max_f32 v4, v15, v4
    v_sub_f32 v4, 0, v4
    v_and_b32 v5, 0xffff0000, v4
    v_sub_f32 v4, v4, v5
    v_and_b32 v6, 0xffff0000, v4
    v_sub_f32 v4, v4, v6
    s_mov_b32 s3, 0x07060302
    v_perm_b32 v5, v6, v5, s3
    v_lshrrev_b32 v4, 16, v4
    v_cndmask_b32 v158, v158, v5, s[44:45]
    v_cndmask_b32 v159, v159, v4, s[44:45]
    s_waitcnt vmcnt(8) lgkmcnt(0)
.p2align 6
L_attn_loop:
    v_mfma_f32_32x32x16_bf16 v[68:83], v[20:23], v[152:155], 0
    ds_read_b128 v[32:35], v9 offset:14400
    v_exp_f32 v52, v52
    v_exp_f32 v53, v53
    v_exp_f32 v54, v54
    v_exp_f32 v55, v55
    v_mfma_f32_32x32x16_bf16 v[100:115], v[40:43], v[48:51], v[100:115]
    ds_read_b128 v[40:43], v9 offset:15424
    v_exp_f32 v56, v56
    v_cvt_pk_bf16_f32 v44, v52, v53
    v_exp_f32 v57, v57
    v_cvt_pk_bf16_f32 v45, v54, v55
    v_exp_f32 v58, v58
    v_exp_f32 v59, v59
    v_mfma_f32_32x32x8_bf16 v[68:83], v[16:17], v[158:159], v[68:83]
    v_exp_f32 v60, v60
    v_cvt_pk_bf16_f32 v46, v56, v57
    v_exp_f32 v61, v61
    v_cvt_pk_bf16_f32 v47, v58, v59
    v_exp_f32 v62, v62
    v_exp_f32 v63, v63
    v_mfma_f32_32x32x16_bf16 v[84:99], v[28:31], v[44:47], v[84:99]
    ds_read_b128 v[20:23], v9 offset:26752
    v_exp_f32 v64, v64
    v_cvt_pk_bf16_f32 v48, v60, v61
    v_exp_f32 v65, v65
    v_cvt_pk_bf16_f32 v49, v62, v63
    v_exp_f32 v66, v66
    v_exp_f32 v67, v67
    v_cvt_pk_bf16_f32 v50, v64, v65
    v_cvt_pk_bf16_f32 v51, v66, v67
    v_mfma_f32_32x32x16_bf16 v[52:67], v[24:27], v[148:151], 0
    ds_read_b64 v[16:17], v11 offset:26752
    v_exp_f32 v68, v68
    v_exp_f32 v69, v69
    v_exp_f32 v70, v70
    v_exp_f32 v71, v71
    v_mfma_f32_32x32x16_bf16 v[84:99], v[36:39], v[48:51], v[84:99]
    s_barrier
    v_exp_f32 v72, v72
    v_cvt_pk_bf16_f32 v44, v68, v69
    v_exp_f32 v73, v73
    v_cvt_pk_bf16_f32 v45, v70, v71
    v_exp_f32 v74, v74
    v_exp_f32 v75, v75
    v_mfma_f32_32x32x8_bf16 v[52:67], v[18:19], v[156:157], v[52:67]
    v_exp_f32 v76, v76
    v_cvt_pk_bf16_f32 v46, v72, v73
    v_exp_f32 v77, v77
    v_cvt_pk_bf16_f32 v47, v74, v75
    v_exp_f32 v78, v78
    v_exp_f32 v79, v79
    v_mfma_f32_32x32x16_bf16 v[100:115], v[28:31], v[44:47], v[100:115]
    s_waitcnt lgkmcnt(0)
    v_exp_f32 v80, v80
    v_cvt_pk_bf16_f32 v48, v76, v77
    v_exp_f32 v81, v81
    v_cvt_pk_bf16_f32 v49, v78, v79
    v_exp_f32 v82, v82
    v_exp_f32 v83, v83
    v_cvt_pk_bf16_f32 v50, v80, v81
    v_cvt_pk_bf16_f32 v51, v82, v83
    v_mfma_f32_32x32x16_bf16 v[68:83], v[24:27], v[152:155], 0
    ds_read_b128 v[28:31], v9 offset:27776
    v_exp_f32 v52, v52
    v_exp_f32 v53, v53
    v_exp_f32 v54, v54
    v_exp_f32 v55, v55
    v_mfma_f32_32x32x16_bf16 v[100:115], v[36:39], v[48:51], v[100:115]
    ds_read_b128 v[36:39], v9 offset:28800
    v_exp_f32 v56, v56
    v_cvt_pk_bf16_f32 v44, v52, v53
    v_exp_f32 v57, v57
    v_cvt_pk_bf16_f32 v45, v54, v55
    v_exp_f32 v58, v58
    v_exp_f32 v59, v59
    v_mfma_f32_32x32x8_bf16 v[68:83], v[18:19], v[158:159], v[68:83]
    v_exp_f32 v60, v60
    v_cvt_pk_bf16_f32 v46, v56, v57
    v_exp_f32 v61, v61
    v_cvt_pk_bf16_f32 v47, v58, v59
    v_exp_f32 v62, v62
    v_exp_f32 v63, v63
    v_mfma_f32_32x32x16_bf16 v[84:99], v[32:35], v[44:47], v[84:99]
    ds_read_b128 v[24:27], v9 offset:40128
    v_exp_f32 v64, v64
    v_cvt_pk_bf16_f32 v48, v60, v61
    v_exp_f32 v65, v65
    v_cvt_pk_bf16_f32 v49, v62, v63
    v_exp_f32 v66, v66
    v_exp_f32 v67, v67
    v_cvt_pk_bf16_f32 v50, v64, v65
    v_cvt_pk_bf16_f32 v51, v66, v67
    v_mfma_f32_32x32x16_bf16 v[52:67], v[20:23], v[148:151], 0
    ds_read_b64 v[18:19], v11 offset:40128
    v_exp_f32 v68, v68
    v_exp_f32 v69, v69
    v_exp_f32 v70, v70
    v_exp_f32 v71, v71
    v_mfma_f32_32x32x16_bf16 v[84:99], v[40:43], v[48:51], v[84:99]
    s_waitcnt vmcnt(0)
    v_exp_f32 v72, v72
    v_cvt_pk_bf16_f32 v44, v68, v69
    v_exp_f32 v73, v73
    v_cvt_pk_bf16_f32 v45, v70, v71
    v_exp_f32 v74, v74
    v_exp_f32 v75, v75
    v_mfma_f32_32x32x8_bf16 v[52:67], v[16:17], v[156:157], v[52:67]
    v_exp_f32 v76, v76
    v_cvt_pk_bf16_f32 v46, v72, v73
    v_exp_f32 v77, v77
    v_cvt_pk_bf16_f32 v47, v74, v75
    v_exp_f32 v78, v78
    v_exp_f32 v79, v79
    v_mfma_f32_32x32x16_bf16 v[100:115], v[32:35], v[44:47], v[100:115]
    s_waitcnt lgkmcnt(0)
    v_exp_f32 v80, v80
    v_cvt_pk_bf16_f32 v48, v76, v77
    v_exp_f32 v81, v81
    v_cvt_pk_bf16_f32 v49, v78, v79
    v_exp_f32 v82, v82
    v_exp_f32 v83, v83
    v_cvt_pk_bf16_f32 v50, v80, v81
    v_cvt_pk_bf16_f32 v51, v82, v83
    v_mfma_f32_32x32x16_bf16 v[68:83], v[20:23], v[152:155], 0
    ds_read_b128 v[32:35], v9 offset:41152
    v_exp_f32 v52, v52
    v_exp_f32 v53, v53
    v_exp_f32 v54, v54
    v_exp_f32 v55, v55
    v_mfma_f32_32x32x16_bf16 v[100:115], v[40:43], v[48:51], v[100:115]
    ds_read_b128 v[40:43], v9 offset:42176
    v_exp_f32 v56, v56
    v_cvt_pk_bf16_f32 v44, v52, v53
    v_exp_f32 v57, v57
    v_cvt_pk_bf16_f32 v45, v54, v55
    v_exp_f32 v58, v58
    v_exp_f32 v59, v59
    v_mfma_f32_32x32x8_bf16 v[68:83], v[16:17], v[158:159], v[68:83]
    v_exp_f32 v60, v60
    v_cvt_pk_bf16_f32 v46, v56, v57
    v_exp_f32 v61, v61
    v_cvt_pk_bf16_f32 v47, v58, v59
    v_exp_f32 v62, v62
    v_exp_f32 v63, v63
    v_mfma_f32_32x32x16_bf16 v[84:99], v[28:31], v[44:47], v[84:99]
    ds_read_b128 v[20:23], v10 offset:0
    v_exp_f32 v64, v64
    v_cvt_pk_bf16_f32 v48, v60, v61
    v_exp_f32 v65, v65
    v_cvt_pk_bf16_f32 v49, v62, v63
    v_exp_f32 v66, v66
    v_exp_f32 v67, v67
    v_cvt_pk_bf16_f32 v50, v64, v65
    v_cvt_pk_bf16_f32 v51, v66, v67
    v_mfma_f32_32x32x16_bf16 v[52:67], v[24:27], v[148:151], 0
    ds_read_b64 v[16:17], v12 offset:0
    v_exp_f32 v68, v68
    v_exp_f32 v69, v69
    v_exp_f32 v70, v70
    v_exp_f32 v71, v71
    v_mfma_f32_32x32x16_bf16 v[84:99], v[36:39], v[48:51], v[84:99]
    s_barrier
    v_exp_f32 v72, v72
    v_cvt_pk_bf16_f32 v44, v68, v69
    v_exp_f32 v73, v73
    v_cvt_pk_bf16_f32 v45, v70, v71
    v_exp_f32 v74, v74
    v_exp_f32 v75, v75
    v_mfma_f32_32x32x8_bf16 v[52:67], v[18:19], v[156:157], v[52:67]
    v_exp_f32 v76, v76
    v_cvt_pk_bf16_f32 v46, v72, v73
    v_exp_f32 v77, v77
    v_cvt_pk_bf16_f32 v47, v74, v75
    v_exp_f32 v78, v78
    v_exp_f32 v79, v79
    v_mfma_f32_32x32x16_bf16 v[100:115], v[28:31], v[44:47], v[100:115]
    s_waitcnt lgkmcnt(0)
    v_exp_f32 v80, v80
    v_cvt_pk_bf16_f32 v48, v76, v77
    v_exp_f32 v81, v81
    v_cvt_pk_bf16_f32 v49, v78, v79
    v_exp_f32 v82, v82
    v_exp_f32 v83, v83
    v_cvt_pk_bf16_f32 v50, v80, v81
    v_cvt_pk_bf16_f32 v51, v82, v83
    v_mfma_f32_32x32x16_bf16 v[68:83], v[24:27], v[152:155], 0
    ds_read_b128 v[28:31], v10 offset:1024
    v_exp_f32 v52, v52
    v_exp_f32 v53, v53
    v_exp_f32 v54, v54
    v_exp_f32 v55, v55
    v_mfma_f32_32x32x16_bf16 v[100:115], v[36:39], v[48:51], v[100:115]
    ds_read_b128 v[36:39], v10 offset:2048
    v_exp_f32 v56, v56
    v_cvt_pk_bf16_f32 v44, v52, v53
    v_exp_f32 v57, v57
    v_cvt_pk_bf16_f32 v45, v54, v55
    v_exp_f32 v58, v58
    v_exp_f32 v59, v59
    v_mfma_f32_32x32x8_bf16 v[68:83], v[18:19], v[158:159], v[68:83]
    v_exp_f32 v60, v60
    v_cvt_pk_bf16_f32 v46, v56, v57
    v_exp_f32 v61, v61
    v_cvt_pk_bf16_f32 v47, v58, v59
    v_exp_f32 v62, v62
    v_exp_f32 v63, v63
    v_mfma_f32_32x32x16_bf16 v[84:99], v[32:35], v[44:47], v[84:99]
    ds_read_b128 v[24:27], v10 offset:13376
    v_exp_f32 v64, v64
    v_cvt_pk_bf16_f32 v48, v60, v61
    v_exp_f32 v65, v65
    v_cvt_pk_bf16_f32 v49, v62, v63
    v_exp_f32 v66, v66
    v_exp_f32 v67, v67
    v_cvt_pk_bf16_f32 v50, v64, v65
    v_cvt_pk_bf16_f32 v51, v66, v67
    v_mfma_f32_32x32x16_bf16 v[52:67], v[20:23], v[148:151], 0
    ds_read_b64 v[18:19], v12 offset:13376
    v_exp_f32 v68, v68
    v_exp_f32 v69, v69
    v_exp_f32 v70, v70
    v_exp_f32 v71, v71
    v_mfma_f32_32x32x16_bf16 v[84:99], v[40:43], v[48:51], v[84:99]
    v_exp_f32 v72, v72
    v_cvt_pk_bf16_f32 v44, v68, v69
    v_exp_f32 v73, v73
    v_cvt_pk_bf16_f32 v45, v70, v71
    v_exp_f32 v74, v74
    v_exp_f32 v75, v75
    v_mfma_f32_32x32x8_bf16 v[52:67], v[16:17], v[156:157], v[52:67]
    v_exp_f32 v76, v76
    v_cvt_pk_bf16_f32 v46, v72, v73
    v_exp_f32 v77, v77
    v_cvt_pk_bf16_f32 v47, v74, v75
    v_exp_f32 v78, v78
    v_exp_f32 v79, v79
    v_mfma_f32_32x32x16_bf16 v[100:115], v[32:35], v[44:47], v[100:115]
    s_waitcnt lgkmcnt(0)
    v_exp_f32 v80, v80
    v_cvt_pk_bf16_f32 v48, v76, v77
    v_exp_f32 v81, v81
    v_cvt_pk_bf16_f32 v49, v78, v79
    v_exp_f32 v82, v82
    v_exp_f32 v83, v83
    v_cvt_pk_bf16_f32 v50, v80, v81
    v_cvt_pk_bf16_f32 v51, v82, v83
    v_mfma_f32_32x32x16_bf16 v[68:83], v[20:23], v[152:155], 0
    ds_read_b128 v[32:35], v10 offset:14400
    v_exp_f32 v52, v52
    v_exp_f32 v53, v53
    v_exp_f32 v54, v54
    v_exp_f32 v55, v55
    v_mfma_f32_32x32x16_bf16 v[100:115], v[40:43], v[48:51], v[100:115]
    ds_read_b128 v[40:43], v10 offset:15424
    v_exp_f32 v56, v56
    v_cvt_pk_bf16_f32 v44, v52, v53
    v_exp_f32 v57, v57
    v_cvt_pk_bf16_f32 v45, v54, v55
    v_exp_f32 v58, v58
    v_exp_f32 v59, v59
    v_mfma_f32_32x32x8_bf16 v[68:83], v[16:17], v[158:159], v[68:83]
    v_exp_f32 v60, v60
    v_cvt_pk_bf16_f32 v46, v56, v57
    v_exp_f32 v61, v61
    v_cvt_pk_bf16_f32 v47, v58, v59
    v_exp_f32 v62, v62
    v_exp_f32 v63, v63
    v_mfma_f32_32x32x16_bf16 v[84:99], v[28:31], v[44:47], v[84:99]
    ds_read_b128 v[20:23], v10 offset:26752
    v_exp_f32 v64, v64
    v_cvt_pk_bf16_f32 v48, v60, v61
    v_exp_f32 v65, v65
    v_cvt_pk_bf16_f32 v49, v62, v63
    v_exp_f32 v66, v66
    v_exp_f32 v67, v67
    v_cvt_pk_bf16_f32 v50, v64, v65
    v_cvt_pk_bf16_f32 v51, v66, v67
    v_mfma_f32_32x32x16_bf16 v[52:67], v[24:27], v[148:151], 0
    ds_read_b64 v[16:17], v12 offset:26752
    v_exp_f32 v68, v68
    v_exp_f32 v69, v69
    v_exp_f32 v70, v70
    v_exp_f32 v71, v71
    v_mfma_f32_32x32x16_bf16 v[84:99], v[36:39], v[48:51], v[84:99]
    s_barrier
    v_exp_f32 v72, v72
    v_cvt_pk_bf16_f32 v44, v68, v69
    v_exp_f32 v73, v73
    v_cvt_pk_bf16_f32 v45, v70, v71
    v_exp_f32 v74, v74
    v_exp_f32 v75, v75
    v_mfma_f32_32x32x8_bf16 v[52:67], v[18:19], v[156:157], v[52:67]
    v_exp_f32 v76, v76
    v_cvt_pk_bf16_f32 v46, v72, v73
    v_exp_f32 v77, v77
    v_cvt_pk_bf16_f32 v47, v74, v75
    v_exp_f32 v78, v78
    v_exp_f32 v79, v79
    v_mfma_f32_32x32x16_bf16 v[100:115], v[28:31], v[44:47], v[100:115]
    s_waitcnt lgkmcnt(0)
    v_exp_f32 v80, v80
    v_cvt_pk_bf16_f32 v48, v76, v77
    v_exp_f32 v81, v81
    v_cvt_pk_bf16_f32 v49, v78, v79
    v_exp_f32 v82, v82
    v_exp_f32 v83, v83
    v_cvt_pk_bf16_f32 v50, v80, v81
    v_cvt_pk_bf16_f32 v51, v82, v83
    v_mfma_f32_32x32x16_bf16 v[68:83], v[24:27], v[152:155], 0
    ds_read_b128 v[28:31], v10 offset:27776
    v_exp_f32 v52, v52
    v_exp_f32 v53, v53
    v_exp_f32 v54, v54
    v_exp_f32 v55, v55
    v_mfma_f32_32x32x16_bf16 v[100:115], v[36:39], v[48:51], v[100:115]
    ds_read_b128 v[36:39], v10 offset:28800
    v_exp_f32 v56, v56
    v_cvt_pk_bf16_f32 v44, v52, v53
    v_exp_f32 v57, v57
    v_cvt_pk_bf16_f32 v45, v54, v55
    v_exp_f32 v58, v58
    v_exp_f32 v59, v59
    v_mfma_f32_32x32x8_bf16 v[68:83], v[18:19], v[158:159], v[68:83]
    v_exp_f32 v60, v60
    v_cvt_pk_bf16_f32 v46, v56, v57
    v_exp_f32 v61, v61
    v_cvt_pk_bf16_f32 v47, v58, v59
    v_exp_f32 v62, v62
    v_exp_f32 v63, v63
    v_mfma_f32_32x32x16_bf16 v[84:99], v[32:35], v[44:47], v[84:99]
    ds_read_b128 v[24:27], v10 offset:40128
    v_exp_f32 v64, v64
    v_cvt_pk_bf16_f32 v48, v60, v61
    v_exp_f32 v65, v65
    v_cvt_pk_bf16_f32 v49, v62, v63
    v_exp_f32 v66, v66
    v_exp_f32 v67, v67
    v_cvt_pk_bf16_f32 v50, v64, v65
    v_cvt_pk_bf16_f32 v51, v66, v67
    v_mfma_f32_32x32x16_bf16 v[52:67], v[20:23], v[148:151], 0
    ds_read_b64 v[18:19], v12 offset:40128
    v_exp_f32 v68, v68
    v_exp_f32 v69, v69
    v_exp_f32 v70, v70
    v_exp_f32 v71, v71
    v_mfma_f32_32x32x16_bf16 v[84:99], v[40:43], v[48:51], v[84:99]
    v_exp_f32 v72, v72
    v_cvt_pk_bf16_f32 v44, v68, v69
    v_exp_f32 v73, v73
    v_cvt_pk_bf16_f32 v45, v70, v71
    v_exp_f32 v74, v74
    v_exp_f32 v75, v75
    v_mfma_f32_32x32x8_bf16 v[52:67], v[16:17], v[156:157], v[52:67]
    v_exp_f32 v76, v76
    v_cvt_pk_bf16_f32 v46, v72, v73
    v_exp_f32 v77, v77
    v_cvt_pk_bf16_f32 v47, v74, v75
    v_exp_f32 v78, v78
    v_exp_f32 v79, v79
    v_mfma_f32_32x32x16_bf16 v[100:115], v[32:35], v[44:47], v[100:115]
    s_waitcnt lgkmcnt(0)
    v_exp_f32 v80, v80
    v_cvt_pk_bf16_f32 v48, v76, v77
    v_exp_f32 v81, v81
    v_cvt_pk_bf16_f32 v49, v78, v79
    v_exp_f32 v82, v82
    v_exp_f32 v83, v83
    v_cvt_pk_bf16_f32 v50, v80, v81
    v_cvt_pk_bf16_f32 v51, v82, v83
    v_mfma_f32_32x32x16_bf16 v[68:83], v[20:23], v[152:155], 0
    ds_read_b128 v[32:35], v10 offset:41152
    v_exp_f32 v52, v52
    v_exp_f32 v53, v53
    v_exp_f32 v54, v54
    v_exp_f32 v55, v55
    v_mfma_f32_32x32x16_bf16 v[100:115], v[40:43], v[48:51], v[100:115]
    ds_read_b128 v[40:43], v10 offset:42176
    v_exp_f32 v56, v56
    v_cvt_pk_bf16_f32 v44, v52, v53
    v_exp_f32 v57, v57
    v_cvt_pk_bf16_f32 v45, v54, v55
    v_exp_f32 v58, v58
    v_exp_f32 v59, v59
    v_mfma_f32_32x32x8_bf16 v[68:83], v[16:17], v[158:159], v[68:83]
    v_exp_f32 v60, v60
    v_cvt_pk_bf16_f32 v46, v56, v57
    v_exp_f32 v61, v61
    v_cvt_pk_bf16_f32 v47, v58, v59
    v_exp_f32 v62, v62
    v_exp_f32 v63, v63
    v_mfma_f32_32x32x16_bf16 v[84:99], v[28:31], v[44:47], v[84:99]
    ds_read_b128 v[20:23], v9 offset:0
    v_exp_f32 v64, v64
    v_cvt_pk_bf16_f32 v48, v60, v61
    v_exp_f32 v65, v65
    v_cvt_pk_bf16_f32 v49, v62, v63
    v_exp_f32 v66, v66
    v_exp_f32 v67, v67
    v_cvt_pk_bf16_f32 v50, v64, v65
    v_cvt_pk_bf16_f32 v51, v66, v67
    v_mfma_f32_32x32x16_bf16 v[52:67], v[24:27], v[148:151], 0
    ds_read_b64 v[16:17], v11 offset:0
    v_exp_f32 v68, v68
    v_exp_f32 v69, v69
    v_exp_f32 v70, v70
    v_exp_f32 v71, v71
    v_mfma_f32_32x32x16_bf16 v[84:99], v[36:39], v[48:51], v[84:99]
    s_barrier
    v_exp_f32 v72, v72
    v_cvt_pk_bf16_f32 v44, v68, v69
    v_exp_f32 v73, v73
    v_cvt_pk_bf16_f32 v45, v70, v71
    v_exp_f32 v74, v74
    v_exp_f32 v75, v75
    v_mfma_f32_32x32x8_bf16 v[52:67], v[18:19], v[156:157], v[52:67]
    v_exp_f32 v76, v76
    v_cvt_pk_bf16_f32 v46, v72, v73
    v_exp_f32 v77, v77
    v_cvt_pk_bf16_f32 v47, v74, v75
    v_exp_f32 v78, v78
    v_exp_f32 v79, v79
    v_mfma_f32_32x32x16_bf16 v[100:115], v[28:31], v[44:47], v[100:115]
    s_waitcnt lgkmcnt(0)
    v_exp_f32 v80, v80
    v_cvt_pk_bf16_f32 v48, v76, v77
    v_exp_f32 v81, v81
    v_cvt_pk_bf16_f32 v49, v78, v79
    v_exp_f32 v82, v82
    v_exp_f32 v83, v83
    v_cvt_pk_bf16_f32 v50, v80, v81
    v_cvt_pk_bf16_f32 v51, v82, v83
    v_mfma_f32_32x32x16_bf16 v[68:83], v[24:27], v[152:155], 0
    ds_read_b128 v[28:31], v9 offset:1024
    v_exp_f32 v52, v52
    v_exp_f32 v53, v53
    v_exp_f32 v54, v54
    v_exp_f32 v55, v55
    v_mfma_f32_32x32x16_bf16 v[100:115], v[36:39], v[48:51], v[100:115]
    ds_read_b128 v[36:39], v9 offset:2048
    v_exp_f32 v56, v56
    v_cvt_pk_bf16_f32 v44, v52, v53
    v_exp_f32 v57, v57
    v_cvt_pk_bf16_f32 v45, v54, v55
    v_exp_f32 v58, v58
    v_exp_f32 v59, v59
    v_mfma_f32_32x32x8_bf16 v[68:83], v[18:19], v[158:159], v[68:83]
    v_exp_f32 v60, v60
    v_cvt_pk_bf16_f32 v46, v56, v57
    v_exp_f32 v61, v61
    v_cvt_pk_bf16_f32 v47, v58, v59
    v_exp_f32 v62, v62
    v_exp_f32 v63, v63
    v_mfma_f32_32x32x16_bf16 v[84:99], v[32:35], v[44:47], v[84:99]
    ds_read_b128 v[24:27], v9 offset:13376
    v_exp_f32 v64, v64
    v_cvt_pk_bf16_f32 v48, v60, v61
    v_exp_f32 v65, v65
    v_cvt_pk_bf16_f32 v49, v62, v63
    v_exp_f32 v66, v66
    v_exp_f32 v67, v67
    v_cvt_pk_bf16_f32 v50, v64, v65
    v_cvt_pk_bf16_f32 v51, v66, v67
    v_mfma_f32_32x32x16_bf16 v[52:67], v[20:23], v[148:151], 0
    ds_read_b64 v[18:19], v11 offset:13376
    v_exp_f32 v68, v68
    v_exp_f32 v69, v69
    v_exp_f32 v70, v70
    v_exp_f32 v71, v71
    v_mfma_f32_32x32x16_bf16 v[84:99], v[40:43], v[48:51], v[84:99]
    v_exp_f32 v72, v72
    v_cvt_pk_bf16_f32 v44, v68, v69
    v_exp_f32 v73, v73
    v_cvt_pk_bf16_f32 v45, v70, v71
    v_exp_f32 v74, v74
    v_exp_f32 v75, v75
    v_mfma_f32_32x32x8_bf16 v[52:67], v[16:17], v[156:157], v[52:67]
    v_exp_f32 v76, v76
    v_cvt_pk_bf16_f32 v46, v72, v73
    v_exp_f32 v77, v77
    v_cvt_pk_bf16_f32 v47, v74, v75
    v_exp_f32 v78, v78
    v_exp_f32 v79, v79
    v_mfma_f32_32x32x16_bf16 v[100:115], v[32:35], v[44:47], v[100:115]
    s_waitcnt lgkmcnt(0)
    v_exp_f32 v80, v80
    v_cvt_pk_bf16_f32 v48, v76, v77
    v_exp_f32 v81, v81
    v_cvt_pk_bf16_f32 v49, v78, v79
    v_exp_f32 v82, v82
    v_exp_f32 v83, v83
    v_cvt_pk_bf16_f32 v50, v80, v81
    v_cvt_pk_bf16_f32 v51, v82, v83
    s_add_u32 s34, s34, 1
    s_cmp_lt_u32 s34, 8
    s_cbranch_scc1 L_attn_loop
    v_mfma_f32_32x32x16_bf16 v[100:115], v[40:43], v[48:51], v[100:115]
    s_nop 7
    s_nop 7
    s_mov_b32 s4, 0x35800000
    s_mov_b32 s5, 0x5d800000
    s_mov_b32 s3, 0x7f800000
    s_mov_b64 s[46:47], -1
    v_mov_b32 v14, v92
    v_mov_b32 v4, v92
    s_nop 1
    v_permlane32_swap_b32 v4, v14
    s_nop 1
    v_add_f32 v7, abs(v84), abs(v85)
    v_add_f32 v7, v7, abs(v86)
    v_add_f32 v7, v7, abs(v87)
    v_add_f32 v7, v7, abs(v88)
    v_add_f32 v7, v7, abs(v89)
    v_add_f32 v7, v7, abs(v90)
    v_add_f32 v7, v7, abs(v91)
    v_add_f32 v4, abs(v92), abs(v93)
    v_add_f32 v4, v4, abs(v94)
    v_add_f32 v4, v4, abs(v95)
    v_cndmask_b32 v4, v4, 0, s[44:45]
    v_add_f32 v7, v7, v4
    v_cmp_gt_f32 vcc, s3, v7
    s_and_b64 s[46:47], s[46:47], vcc
    v_cmp_le_f32 vcc, s4, v14
    s_and_b64 s[46:47], s[46:47], vcc
    v_cmp_ge_f32 vcc, s5, v14
    s_and_b64 s[46:47], s[46:47], vcc
    v_mov_b32 v15, v108
    v_mov_b32 v4, v108
    s_nop 1
    v_permlane32_swap_b32 v4, v15
    s_nop 1
    v_add_f32 v7, abs(v100), abs(v101)
    v_add_f32 v7, v7, abs(v102)
    v_add_f32 v7, v7, abs(v103)
    v_add_f32 v7, v7, abs(v104)
    v_add_f32 v7, v7, abs(v105)
    v_add_f32 v7, v7, abs(v106)
    v_add_f32 v7, v7, abs(v107)
    v_add_f32 v4, abs(v108), abs(v109)
    v_add_f32 v4, v4, abs(v110)
    v_add_f32 v4, v4, abs(v111)
    v_cndmask_b32 v4, v4, 0, s[44:45]
    v_add_f32 v7, v7, v4
    v_cmp_gt_f32 vcc, s3, v7
    s_and_b64 s[46:47], s[46:47], vcc
    v_cmp_le_f32 vcc, s4, v15
    s_and_b64 s[46:47], s[46:47], vcc
    v_cmp_ge_f32 vcc, s5, v15
    s_and_b64 s[46:47], s[46:47], vcc
    s_cmp_eq_u64 s[46:47], -1
    s_cbranch_scc0 L_attn_slow
L_attn_fin:
    v_lshlrev_b32 v5, 3, v1
    v_lshrrev_b32 v6, 5, v1
    v_mul_u32_u24 v6, 1024, v6
    v_add_u32 v5, v5, v6
    v_rcp_f32 v4, v14
    s_nop 0
    v_mul_f32 v84, v84, v4
    v_mul_f32 v85, v85, v4
    v_mul_f32 v86, v86, v4
    v_mul_f32 v87, v87, v4
    v_mul_f32 v88, v88, v4
    v_mul_f32 v89, v89, v4
    v_mul_f32 v90, v90, v4
    v_mul_f32 v91, v91, v4
    v_mul_f32 v92, v92, v4
    v_mul_f32 v93, v93, v4
    v_mul_f32 v94, v94, v4
    v_mul_f32 v95, v95, v4
    v_cvt_pk_bf16_f32 v52, v84, v85
    v_cvt_pk_bf16_f32 v53, v86, v87
    v_cvt_pk_bf16_f32 v54, v88, v89
    v_cvt_pk_bf16_f32 v55, v90, v91
    v_cvt_pk_bf16_f32 v44, v92, v93
    v_cvt_pk_bf16_f32 v45, v94, v95
    v_permlane32_swap_b32 v52, v54
    v_permlane32_swap_b32 v53, v55
    s_nop 1
    buffer_store_dwordx4 v[52:55], v8, s[8:11], s19 offen offset:0 sc1
    v_rcp_f32 v4, v15
    s_nop 0
    v_mul_f32 v100, v100, v4
    v_mul_f32 v101, v101, v4
    v_mul_f32 v102, v102, v4
    v_mul_f32 v103, v103, v4
    v_mul_f32 v104, v104, v4
    v_mul_f32 v105, v105, v4
    v_mul_f32 v106, v106, v4
    v_mul_f32 v107, v107, v4
    v_mul_f32 v108, v108, v4
    v_mul_f32 v109, v109, v4
    v_mul_f32 v110, v110, v4
    v_mul_f32 v111, v111, v4
    v_cvt_pk_bf16_f32 v68, v100, v101
    v_cvt_pk_bf16_f32 v69, v102, v103
    v_cvt_pk_bf16_f32 v70, v104, v105
    v_cvt_pk_bf16_f32 v71, v106, v107
    v_cvt_pk_bf16_f32 v46, v108, v109
    v_cvt_pk_bf16_f32 v47, v110, v111
    v_permlane32_swap_b32 v68, v70
    v_permlane32_swap_b32 v69, v71
    s_nop 1
    buffer_store_dwordx4 v[68:71], v8, s[8:11], s19 offen offset:1280 sc1
    v_permlane32_swap_b32 v44, v46
    v_permlane32_swap_b32 v45, v47
    s_nop 1
    buffer_store_dwordx2 v[44:45], v5, s[8:11], s19 offen offset:1024 sc1
    v_and_b32 v6, 3, v2
    v_bfe_u32 v7, v2, 2, 1
    v_lshl_add_u32 v6, v7, 3, v6
    v_bfe_u32 v7, v2, 3, 1
    v_lshl_add_u32 v6, v7, 2, v6
    s_lshl_b32 s3, s13, 11
    s_lshl_b32 s4, s15, 2
    s_add_u32 s3, s3, s4
    s_lshr_b32 s4, s12, 1
    s_add_u32 s3, s3, s4
    s_mul_i32 s3, s3, 1280
    s_add_u32 s33, s3, 5242880
    s_and_b32 s4, s12, 1
    s_lshl_b32 s4, s4, 4
    v_add_u32 v6, s4, v6
    v_lshrrev_b32 v4, 1, v3
    s_mov_b32 s5, 81920
    v_mul_lo_u32 v4, v4, s5
    v_and_b32 v7, 1, v3
    v_lshlrev_b32 v7, 9, v7
    v_lshl_add_u32 v7, v6, 4, v7
    v_add_u32 v9, v4, v7
    s_mov_b32 s5, 163840
    v_mul_lo_u32 v4, v3, s5
    v_lshl_add_u32 v10, v6, 3, v4
    v_lshrrev_b32 v4, 1, v3
    v_mul_u32_u24 v4, 2560, v4
    v_and_b32 v7, 1, v3
    v_lshl_add_u32 v4, v7, 7, v4
    v_lshl_add_u32 v12, v2, 3, v4
    v_add_u32 v11, 107008, v12
    s_lshl_b32 s3, s15, 7
    s_lshl_b32 s4, s12, 4
    s_add_u32 s3, s3, s4
    s_mul_i32 s3, s3, 2560
    s_mul_i32 s4, s13, 1280
    s_add_u32 s3, s3, s4
    s_mul_i32 s4, s14, 160
    s_add_u32 s32, s3, s4
    v_mul_u32_u24 v13, 2560, v2
    v_lshl_add_u32 v13, v3, 3, v13
    s_mul_i32 s6, s14, 327680
    s_add_u32 s6, s6, s33
    s_add_u32 s7, s33, 2621440
    s_mov_b32 s16, s64
    s_mov_b32 s17, s65
    s_mov_b32 s18, 5242880
    s_mov_b32 s19, 0x20000
    s_waitcnt vmcnt(0)
    s_barrier
    v_mov_b32 v96, 0
    v_mov_b32 v97, 0
    v_mov_b32 v98, 0
    v_mov_b32 v99, 0
    v_mov_b32 v100, 0
    v_mov_b32 v101, 0
    v_mov_b32 v102, 0
    v_mov_b32 v103, 0
    v_mov_b32 v104, 0
    v_mov_b32 v105, 0
    v_mov_b32 v106, 0
    v_mov_b32 v107, 0
    v_mov_b32 v108, 0
    v_mov_b32 v109, 0
    v_mov_b32 v110, 0
    v_mov_b32 v111, 0
    v_mov_b32 v112, 0
    v_mov_b32 v113, 0
    v_mov_b32 v114, 0
    v_mov_b32 v115, 0
    ds_read_b64_tr_b16 v[116:117], v11 offset:0
    ds_read_b64_tr_b16 v[118:119], v11 offset:1280
    ds_read_b64_tr_b16 v[120:121], v11 offset:256
    ds_read_b64_tr_b16 v[122:123], v11 offset:1536
    ds_read_b64_tr_b16 v[124:125], v11 offset:512
    ds_read_b64_tr_b16 v[126:127], v11 offset:1792
    ds_read_b64_tr_b16 v[128:129], v11 offset:768
    ds_read_b64_tr_b16 v[130:131], v11 offset:2048
    ds_read_b64_tr_b16 v[132:133], v11 offset:1024
    ds_read_b64_tr_b16 v[134:135], v11 offset:2304
    ds_read_b64_tr_b16 v[136:137], v11 offset:5120
    ds_read_b64_tr_b16 v[138:139], v11 offset:6400
    ds_read_b64_tr_b16 v[140:141], v11 offset:5376
    ds_read_b64_tr_b16 v[142:143], v11 offset:6656
    ds_read_b64_tr_b16 v[144:145], v11 offset:5632
    ds_read_b64_tr_b16 v[146:147], v11 offset:6912
    ds_read_b64_tr_b16 v[148:149], v11 offset:5888
    ds_read_b64_tr_b16 v[150:151], v11 offset:7168
    ds_read_b64_tr_b16 v[152:153], v11 offset:6144
    ds_read_b64_tr_b16 v[154:155], v11 offset:7424
    s_barrier
    buffer_load_dwordx4 v[16:19], v9, s[8:11], s6 offen sc1
    s_add_u32 s6, s6, 163840
    s_cmp_eq_u32 s6, s7
    s_cselect_b32 s6, s33, s6
    buffer_load_dwordx4 v[20:23], v9, s[8:11], s6 offen sc1
    s_add_u32 s6, s6, 163840
    s_cmp_eq_u32 s6, s7
    s_cselect_b32 s6, s33, s6
    buffer_load_dwordx4 v[24:27], v9, s[8:11], s6 offen sc1
    s_add_u32 s6, s6, 163840
    s_cmp_eq_u32 s6, s7
    s_cselect_b32 s6, s33, s6
    buffer_load_dwordx4 v[28:31], v9, s[8:11], s6 offen sc1
    s_add_u32 s6, s6, 163840
    s_cmp_eq_u32 s6, s7
    s_cselect_b32 s6, s33, s6
    buffer_load_dwordx4 v[32:35], v9, s[8:11], s6 offen sc1
    s_add_u32 s6, s6, 163840
    s_cmp_eq_u32 s6, s7
    s_cselect_b32 s6, s33, s6
    buffer_load_dwordx4 v[36:39], v9, s[8:11], s6 offen sc1
    s_add_u32 s6, s6, 163840
    s_cmp_eq_u32 s6, s7
    s_cselect_b32 s6, s33, s6
    buffer_load_dwordx4 v[40:43], v9, s[8:11], s6 offen sc1
    s_add_u32 s6, s6, 163840
    s_cmp_eq_u32 s6, s7
    s_cselect_b32 s6, s33, s6
    buffer_load_dwordx4 v[44:47], v9, s[8:11], s6 offen sc1
    s_add_u32 s6, s6, 163840
    s_cmp_eq_u32 s6, s7
    s_cselect_b32 s6, s33, s6
    buffer_load_dwordx4 v[48:51], v9, s[8:11], s6 offen sc1
    s_add_u32 s6, s6, 163840
    s_cmp_eq_u32 s6, s7
    s_cselect_b32 s6, s33, s6
    buffer_load_dwordx4 v[52:55], v9, s[8:11], s6 offen sc1
    s_add_u32 s6, s6, 163840
    s_cmp_eq_u32 s6, s7
    s_cselect_b32 s6, s33, s6
    buffer_load_dwordx4 v[56:59], v9, s[8:11], s6 offen sc1
    s_add_u32 s6, s6, 163840
    s_cmp_eq_u32 s6, s7
    s_cselect_b32 s6, s33, s6
    buffer_load_dwordx4 v[60:63], v9, s[8:11], s6 offen sc1
    s_add_u32 s6, s6, 163840
    s_cmp_eq_u32 s6, s7
    s_cselect_b32 s6, s33, s6
    buffer_load_dwordx4 v[64:67], v9, s[8:11], s6 offen sc1
    s_add_u32 s6, s6, 163840
    s_cmp_eq_u32 s6, s7
    s_cselect_b32 s6, s33, s6
    buffer_load_dwordx4 v[68:71], v9, s[8:11], s6 offen sc1
    s_add_u32 s6, s6, 163840
    s_cmp_eq_u32 s6, s7
    s_cselect_b32 s6, s33, s6
    buffer_load_dwordx4 v[72:75], v9, s[8:11], s6 offen sc1
    s_add_u32 s6, s6, 163840
    s_cmp_eq_u32 s6, s7
    s_cselect_b32 s6, s33, s6
    buffer_load_dwordx4 v[76:79], v9, s[8:11], s6 offen sc1
    s_add_u32 s33, s33, 1024
    s_add_u32 s4, s33, 81920
    buffer_load_dwordx2 v[80:81], v10, s[8:11], s33 offen sc1
    buffer_load_dwordx2 v[82:83], v10, s[8:11], s4 offen sc1
    s_add_u32 s33, s33, 655360
    s_add_u32 s4, s4, 655360
    buffer_load_dwordx2 v[84:85], v10, s[8:11], s33 offen sc1
    buffer_load_dwordx2 v[86:87], v10, s[8:11], s4 offen sc1
    s_add_u32 s33, s33, 655360
    s_add_u32 s4, s4, 655360
    buffer_load_dwordx2 v[88:89], v10, s[8:11], s33 offen sc1
    buffer_load_dwordx2 v[90:91], v10, s[8:11], s4 offen sc1
    s_add_u32 s33, s33, 655360
    s_add_u32 s4, s4, 655360
    buffer_load_dwordx2 v[92:93], v10, s[8:11], s33 offen sc1
    buffer_load_dwordx2 v[94:95], v10, s[8:11], s4 offen sc1
    s_waitcnt vmcnt(23) lgkmcnt(0)
    v_mfma_f32_16x16x32_bf16 v[96:99], v[116:119], v[16:19], v[96:99]
    ds_read_b64_tr_b16 v[116:117], v11 offset:10240
    ds_read_b64_tr_b16 v[118:119], v11 offset:11520
    v_mfma_f32_16x16x32_bf16 v[100:103], v[120:123], v[16:19], v[100:103]
    ds_read_b64_tr_b16 v[120:121], v11 offset:10496
    ds_read_b64_tr_b16 v[122:123], v11 offset:11776
    v_mfma_f32_16x16x32_bf16 v[104:107], v[124:127], v[16:19], v[104:107]
    ds_read_b64_tr_b16 v[124:125], v11 offset:10752
    ds_read_b64_tr_b16 v[126:127], v11 offset:12032
    v_mfma_f32_16x16x32_bf16 v[108:111], v[128:131], v[16:19], v[108:111]
    ds_read_b64_tr_b16 v[128:129], v11 offset:11008
    ds_read_b64_tr_b16 v[130:131], v11 offset:12288
    v_mfma_f32_16x16x32_bf16 v[112:115], v[132:135], v[16:19], v[112:115]
    ds_read_b64_tr_b16 v[132:133], v11 offset:11264
    ds_read_b64_tr_b16 v[134:135], v11 offset:12544
    s_waitcnt vmcnt(22)
    v_mfma_f32_16x16x32_bf16 v[96:99], v[136:139], v[20:23], v[96:99]
    ds_read_b64_tr_b16 v[136:137], v11 offset:15360
    ds_read_b64_tr_b16 v[138:139], v11 offset:16640
    v_mfma_f32_16x16x32_bf16 v[100:103], v[140:143], v[20:23], v[100:103]
    ds_read_b64_tr_b16 v[140:141], v11 offset:15616
    ds_read_b64_tr_b16 v[142:143], v11 offset:16896
    v_mfma_f32_16x16x32_bf16 v[104:107], v[144:147], v[20:23], v[104:107]
    ds_read_b64_tr_b16 v[144:145], v11 offset:15872
    ds_read_b64_tr_b16 v[146:147], v11 offset:17152
    v_mfma_f32_16x16x32_bf16 v[108:111], v[148:151], v[20:23], v[108:111]
    ds_read_b64_tr_b16 v[148:149], v11 offset:16128
    ds_read_b64_tr_b16 v[150:151], v11 offset:17408
    v_mfma_f32_16x16x32_bf16 v[112:115], v[152:155], v[20:23], v[112:115]
    ds_read_b64_tr_b16 v[152:153], v11 offset:16384
    ds_read_b64_tr_b16 v[154:155], v11 offset:17664
    s_waitcnt vmcnt(21)
    s_waitcnt lgkmcnt(14)
    v_mfma_f32_16x16x32_bf16 v[96:99], v[116:119], v[24:27], v[96:99]
    ds_read_b64_tr_b16 v[116:117], v11 offset:20480
    ds_read_b64_tr_b16 v[118:119], v11 offset:21760
    v_mfma_f32_16x16x32_bf16 v[100:103], v[120:123], v[24:27], v[100:103]
    ds_read_b64_tr_b16 v[120:121], v11 offset:20736
    ds_read_b64_tr_b16 v[122:123], v11 offset:22016
    v_mfma_f32_16x16x32_bf16 v[104:107], v[124:127], v[24:27], v[104:107]
    ds_read_b64_tr_b16 v[124:125], v11 offset:20992
    ds_read_b64_tr_b16 v[126:127], v11 offset:22272
    s_waitcnt lgkmcnt(14)
    v_mfma_f32_16x16x32_bf16 v[108:111], v[128:131], v[24:27], v[108:111]
    ds_read_b64_tr_b16 v[128:129], v11 offset:21248
    ds_read_b64_tr_b16 v[130:131], v11 offset:22528
    v_mfma_f32_16x16x32_bf16 v[112:115], v[132:135], v[24:27], v[112:115]
    ds_read_b64_tr_b16 v[132:133], v11 offset:21504
    ds_read_b64_tr_b16 v[134:135], v11 offset:22784
    s_waitcnt vmcnt(20)
    v_mfma_f32_16x16x32_bf16 v[96:99], v[136:139], v[28:31], v[96:99]
    ds_read_b64_tr_b16 v[136:137], v11 offset:25600
    ds_read_b64_tr_b16 v[138:139], v11 offset:26880
    s_waitcnt lgkmcnt(14)
    v_mfma_f32_16x16x32_bf16 v[100:103], v[140:143], v[28:31], v[100:103]
    ds_read_b64_tr_b16 v[140:141], v11 offset:25856
    ds_read_b64_tr_b16 v[142:143], v11 offset:27136
    v_mfma_f32_16x16x32_bf16 v[104:107], v[144:147], v[28:31], v[104:107]
    ds_read_b64_tr_b16 v[144:145], v11 offset:26112
    ds_read_b64_tr_b16 v[146:147], v11 offset:27392
    v_mfma_f32_16x16x32_bf16 v[108:111], v[148:151], v[28:31], v[108:111]
    ds_read_b64_tr_b16 v[148:149], v11 offset:26368
    ds_read_b64_tr_b16 v[150:151], v11 offset:27648
    s_waitcnt lgkmcnt(14)
    v_mfma_f32_16x16x32_bf16 v[112:115], v[152:155], v[28:31], v[112:115]
    ds_read_b64_tr_b16 v[152:153], v11 offset:26624
    ds_read_b64_tr_b16 v[154:155], v11 offset:27904
    s_waitcnt vmcnt(19)
    v_mfma_f32_16x16x32_bf16 v[96:99], v[116:119], v[32:35], v[96:99]
    ds_read_b64_tr_b16 v[116:117], v11 offset:30720
    ds_read_b64_tr_b16 v[118:119], v11 offset:32000
    v_mfma_f32_16x16x32_bf16 v[100:103], v[120:123], v[32:35], v[100:103]
    ds_read_b64_tr_b16 v[120:121], v11 offset:30976
    ds_read_b64_tr_b16 v[122:123], v11 offset:32256
    s_waitcnt lgkmcnt(14)
    v_mfma_f32_16x16x32_bf16 v[104:107], v[124:127], v[32:35], v[104:107]
    ds_read_b64_tr_b16 v[124:125], v11 offset:31232
    ds_read_b64_tr_b16 v[126:127], v11 offset:32512
    v_mfma_f32_16x16x32_bf16 v[108:111], v[128:131], v[32:35], v[108:111]
    ds_read_b64_tr_b16 v[128:129], v11 offset:31488
    ds_read_b64_tr_b16 v[130:131], v11 offset:32768
    v_mfma_f32_16x16x32_bf16 v[112:115], v[132:135], v[32:35], v[112:115]
    ds_read_b64_tr_b16 v[132:133], v11 offset:31744
    ds_read_b64_tr_b16 v[134:135], v11 offset:33024
    s_waitcnt vmcnt(18)
    s_waitcnt lgkmcnt(14)
    v_mfma_f32_16x16x32_bf16 v[96:99], v[136:139], v[36:39], v[96:99]
    ds_read_b64_tr_b16 v[136:137], v11 offset:35840
    ds_read_b64_tr_b16 v[138:139], v11 offset:37120
    v_mfma_f32_16x16x32_bf16 v[100:103], v[140:143], v[36:39], v[100:103]
    ds_read_b64_tr_b16 v[140:141], v11 offset:36096
    ds_read_b64_tr_b16 v[142:143], v11 offset:37376
    v_mfma_f32_16x16x32_bf16 v[104:107], v[144:147], v[36:39], v[104:107]
    ds_read_b64_tr_b16 v[144:145], v11 offset:36352
    ds_read_b64_tr_b16 v[146:147], v11 offset:37632
    s_waitcnt lgkmcnt(14)
    v_mfma_f32_16x16x32_bf16 v[108:111], v[148:151], v[36:39], v[108:111]
    ds_read_b64_tr_b16 v[148:149], v11 offset:36608
    ds_read_b64_tr_b16 v[150:151], v11 offset:37888
    v_mfma_f32_16x16x32_bf16 v[112:115], v[152:155], v[36:39], v[112:115]
    ds_read_b64_tr_b16 v[152:153], v11 offset:36864
    ds_read_b64_tr_b16 v[154:155], v11 offset:38144
    s_waitcnt vmcnt(17)
    v_mfma_f32_16x16x32_bf16 v[96:99], v[116:119], v[40:43], v[96:99]
    ds_read_b64_tr_b16 v[116:117], v11 offset:40960
    ds_read_b64_tr_b16 v[118:119], v11 offset:42240
    s_waitcnt lgkmcnt(14)
    v_mfma_f32_16x16x32_bf16 v[100:103], v[120:123], v[40:43], v[100:103]
    ds_read_b64_tr_b16 v[120:121], v11 offset:41216
    ds_read_b64_tr_b16 v[122:123], v11 offset:42496
    v_mfma_f32_16x16x32_bf16 v[104:107], v[124:127], v[40:43], v[104:107]
    ds_read_b64_tr_b16 v[124:125], v11 offset:41472
    ds_read_b64_tr_b16 v[126:127], v11 offset:42752
    v_mfma_f32_16x16x32_bf16 v[108:111], v[128:131], v[40:43], v[108:111]
    ds_read_b64_tr_b16 v[128:129], v11 offset:41728
    ds_read_b64_tr_b16 v[130:131], v11 offset:43008
    s_waitcnt lgkmcnt(14)
    v_mfma_f32_16x16x32_bf16 v[112:115], v[132:135], v[40:43], v[112:115]
    ds_read_b64_tr_b16 v[132:133], v11 offset:41984
    ds_read_b64_tr_b16 v[134:135], v11 offset:43264
    s_waitcnt vmcnt(16)
    v_mfma_f32_16x16x32_bf16 v[96:99], v[136:139], v[44:47], v[96:99]
    ds_read_b64_tr_b16 v[136:137], v11 offset:46080
    ds_read_b64_tr_b16 v[138:139], v11 offset:47360
    v_mfma_f32_16x16x32_bf16 v[100:103], v[140:143], v[44:47], v[100:103]
    ds_read_b64_tr_b16 v[140:141], v11 offset:46336
    ds_read_b64_tr_b16 v[142:143], v11 offset:47616
    s_waitcnt lgkmcnt(14)
    v_mfma_f32_16x16x32_bf16 v[104:107], v[144:147], v[44:47], v[104:107]
    ds_read_b64_tr_b16 v[144:145], v11 offset:46592
    ds_read_b64_tr_b16 v[146:147], v11 offset:47872
    v_mfma_f32_16x16x32_bf16 v[108:111], v[148:151], v[44:47], v[108:111]
    ds_read_b64_tr_b16 v[148:149], v11 offset:46848
    ds_read_b64_tr_b16 v[150:151], v11 offset:48128
    v_mfma_f32_16x16x32_bf16 v[112:115], v[152:155], v[44:47], v[112:115]
    ds_read_b64_tr_b16 v[152:153], v11 offset:47104
    ds_read_b64_tr_b16 v[154:155], v11 offset:48384
    s_waitcnt vmcnt(15)
    s_waitcnt lgkmcnt(14)
    v_mfma_f32_16x16x32_bf16 v[96:99], v[116:119], v[48:51], v[96:99]
    ds_read_b64_tr_b16 v[116:117], v11 offset:51200
    ds_read_b64_tr_b16 v[118:119], v11 offset:52480
    v_mfma_f32_16x16x32_bf16 v[100:103], v[120:123], v[48:51], v[100:103]
    ds_read_b64_tr_b16 v[120:121], v11 offset:51456
    ds_read_b64_tr_b16 v[122:123], v11 offset:52736
    v_mfma_f32_16x16x32_bf16 v[104:107], v[124:127], v[48:51], v[104:107]
    ds_read_b64_tr_b16 v[124:125], v11 offset:51712
    ds_read_b64_tr_b16 v[126:127], v11 offset:52992
    s_waitcnt lgkmcnt(14)
    v_mfma_f32_16x16x32_bf16 v[108:111], v[128:131], v[48:51], v[108:111]
    ds_read_b64_tr_b16 v[128:129], v11 offset:51968
    ds_read_b64_tr_b16 v[130:131], v11 offset:53248
    v_mfma_f32_16x16x32_bf16 v[112:115], v[132:135], v[48:51], v[112:115]
    ds_read_b64_tr_b16 v[132:133], v11 offset:52224
    ds_read_b64_tr_b16 v[134:135], v11 offset:53504
    s_waitcnt vmcnt(14)
    v_mfma_f32_16x16x32_bf16 v[96:99], v[136:139], v[52:55], v[96:99]
    ds_read_b64_tr_b16 v[136:137], v12 offset:0
    ds_read_b64_tr_b16 v[138:139], v12 offset:1280
    s_waitcnt lgkmcnt(14)
    v_mfma_f32_16x16x32_bf16 v[100:103], v[140:143], v[52:55], v[100:103]
    ds_read_b64_tr_b16 v[140:141], v12 offset:256
    ds_read_b64_tr_b16 v[142:143], v12 offset:1536
    v_mfma_f32_16x16x32_bf16 v[104:107], v[144:147], v[52:55], v[104:107]
    ds_read_b64_tr_b16 v[144:145], v12 offset:512
    ds_read_b64_tr_b16 v[146:147], v12 offset:1792
    v_mfma_f32_16x16x32_bf16 v[108:111], v[148:151], v[52:55], v[108:111]
    ds_read_b64_tr_b16 v[148:149], v12 offset:768
    ds_read_b64_tr_b16 v[150:151], v12 offset:2048
    s_waitcnt lgkmcnt(14)
    v_mfma_f32_16x16x32_bf16 v[112:115], v[152:155], v[52:55], v[112:115]
    ds_read_b64_tr_b16 v[152:153], v12 offset:1024
    ds_read_b64_tr_b16 v[154:155], v12 offset:2304
    s_waitcnt vmcnt(13)
    v_mfma_f32_16x16x32_bf16 v[96:99], v[116:119], v[56:59], v[96:99]
    ds_read_b64_tr_b16 v[116:117], v12 offset:5120
    ds_read_b64_tr_b16 v[118:119], v12 offset:6400
    v_mfma_f32_16x16x32_bf16 v[100:103], v[120:123], v[56:59], v[100:103]
    ds_read_b64_tr_b16 v[120:121], v12 offset:5376
    ds_read_b64_tr_b16 v[122:123], v12 offset:6656
    s_waitcnt lgkmcnt(14)
    v_mfma_f32_16x16x32_bf16 v[104:107], v[124:127], v[56:59], v[104:107]
    ds_read_b64_tr_b16 v[124:125], v12 offset:5632
    ds_read_b64_tr_b16 v[126:127], v12 offset:6912
    v_mfma_f32_16x16x32_bf16 v[108:111], v[128:131], v[56:59], v[108:111]
    ds_read_b64_tr_b16 v[128:129], v12 offset:5888
    ds_read_b64_tr_b16 v[130:131], v12 offset:7168
    v_mfma_f32_16x16x32_bf16 v[112:115], v[132:135], v[56:59], v[112:115]
    ds_read_b64_tr_b16 v[132:133], v12 offset:6144
    ds_read_b64_tr_b16 v[134:135], v12 offset:7424
    s_waitcnt vmcnt(12)
    s_waitcnt lgkmcnt(14)
    v_mfma_f32_16x16x32_bf16 v[96:99], v[136:139], v[60:63], v[96:99]
    ds_read_b64_tr_b16 v[136:137], v12 offset:10240
    ds_read_b64_tr_b16 v[138:139], v12 offset:11520
    v_mfma_f32_16x16x32_bf16 v[100:103], v[140:143], v[60:63], v[100:103]
    ds_read_b64_tr_b16 v[140:141], v12 offset:10496
    ds_read_b64_tr_b16 v[142:143], v12 offset:11776
    v_mfma_f32_16x16x32_bf16 v[104:107], v[144:147], v[60:63], v[104:107]
    ds_read_b64_tr_b16 v[144:145], v12 offset:10752
    ds_read_b64_tr_b16 v[146:147], v12 offset:12032
    s_waitcnt lgkmcnt(14)
    v_mfma_f32_16x16x32_bf16 v[108:111], v[148:151], v[60:63], v[108:111]
    ds_read_b64_tr_b16 v[148:149], v12 offset:11008
    ds_read_b64_tr_b16 v[150:151], v12 offset:12288
    v_mfma_f32_16x16x32_bf16 v[112:115], v[152:155], v[60:63], v[112:115]
    ds_read_b64_tr_b16 v[152:153], v12 offset:11264
    ds_read_b64_tr_b16 v[154:155], v12 offset:12544
    s_waitcnt vmcnt(11)
    v_mfma_f32_16x16x32_bf16 v[96:99], v[116:119], v[64:67], v[96:99]
    ds_read_b64_tr_b16 v[116:117], v12 offset:15360
    ds_read_b64_tr_b16 v[118:119], v12 offset:16640
    s_waitcnt lgkmcnt(14)
    v_mfma_f32_16x16x32_bf16 v[100:103], v[120:123], v[64:67], v[100:103]
    ds_read_b64_tr_b16 v[120:121], v12 offset:15616
    ds_read_b64_tr_b16 v[122:123], v12 offset:16896
    v_mfma_f32_16x16x32_bf16 v[104:107], v[124:127], v[64:67], v[104:107]
    ds_read_b64_tr_b16 v[124:125], v12 offset:15872
    ds_read_b64_tr_b16 v[126:127], v12 offset:17152
    v_mfma_f32_16x16x32_bf16 v[108:111], v[128:131], v[64:67], v[108:111]
    ds_read_b64_tr_b16 v[128:129], v12 offset:16128
    ds_read_b64_tr_b16 v[130:131], v12 offset:17408
    s_waitcnt lgkmcnt(14)
    v_mfma_f32_16x16x32_bf16 v[112:115], v[132:135], v[64:67], v[112:115]
    ds_read_b64_tr_b16 v[132:133], v12 offset:16384
    ds_read_b64_tr_b16 v[134:135], v12 offset:17664
    s_waitcnt vmcnt(10)
    v_mfma_f32_16x16x32_bf16 v[96:99], v[136:139], v[68:71], v[96:99]
    ds_read_b64_tr_b16 v[136:137], v12 offset:20480
    ds_read_b64_tr_b16 v[138:139], v12 offset:21760
    v_mfma_f32_16x16x32_bf16 v[100:103], v[140:143], v[68:71], v[100:103]
    ds_read_b64_tr_b16 v[140:141], v12 offset:20736
    ds_read_b64_tr_b16 v[142:143], v12 offset:22016
    s_waitcnt lgkmcnt(14)
    v_mfma_f32_16x16x32_bf16 v[104:107], v[144:147], v[68:71], v[104:107]
    ds_read_b64_tr_b16 v[144:145], v12 offset:20992
    ds_read_b64_tr_b16 v[146:147], v12 offset:22272
    v_mfma_f32_16x16x32_bf16 v[108:111], v[148:151], v[68:71], v[108:111]
    ds_read_b64_tr_b16 v[148:149], v12 offset:21248
    ds_read_b64_tr_b16 v[150:151], v12 offset:22528
    v_mfma_f32_16x16x32_bf16 v[112:115], v[152:155], v[68:71], v[112:115]
    ds_read_b64_tr_b16 v[152:153], v12 offset:21504
    ds_read_b64_tr_b16 v[154:155], v12 offset:22784
    s_waitcnt vmcnt(9)
    s_waitcnt lgkmcnt(14)
    v_mfma_f32_16x16x32_bf16 v[96:99], v[116:119], v[72:75], v[96:99]
    ds_read_b64_tr_b16 v[116:117], v12 offset:25600
    ds_read_b64_tr_b16 v[118:119], v12 offset:26880
    v_mfma_f32_16x16x32_bf16 v[100:103], v[120:123], v[72:75], v[100:103]
    ds_read_b64_tr_b16 v[120:121], v12 offset:25856
    ds_read_b64_tr_b16 v[122:123], v12 offset:27136
    v_mfma_f32_16x16x32_bf16 v[104:107], v[124:127], v[72:75], v[104:107]
    ds_read_b64_tr_b16 v[124:125], v12 offset:26112
    ds_read_b64_tr_b16 v[126:127], v12 offset:27392
    s_waitcnt lgkmcnt(14)
    v_mfma_f32_16x16x32_bf16 v[108:111], v[128:131], v[72:75], v[108:111]
    ds_read_b64_tr_b16 v[128:129], v12 offset:26368
    ds_read_b64_tr_b16 v[130:131], v12 offset:27648
    v_mfma_f32_16x16x32_bf16 v[112:115], v[132:135], v[72:75], v[112:115]
    ds_read_b64_tr_b16 v[132:133], v12 offset:26624
    ds_read_b64_tr_b16 v[134:135], v12 offset:27904
    s_waitcnt vmcnt(8)
    v_mfma_f32_16x16x32_bf16 v[96:99], v[136:139], v[76:79], v[96:99]
    ds_read_b64_tr_b16 v[136:137], v12 offset:30720
    ds_read_b64_tr_b16 v[138:139], v12 offset:32000
    s_waitcnt lgkmcnt(14)
    v_mfma_f32_16x16x32_bf16 v[100:103], v[140:143], v[76:79], v[100:103]
    ds_read_b64_tr_b16 v[140:141], v12 offset:30976
    ds_read_b64_tr_b16 v[142:143], v12 offset:32256
    v_mfma_f32_16x16x32_bf16 v[104:107], v[144:147], v[76:79], v[104:107]
    ds_read_b64_tr_b16 v[144:145], v12 offset:31232
    ds_read_b64_tr_b16 v[146:147], v12 offset:32512
    v_mfma_f32_16x16x32_bf16 v[108:111], v[148:151], v[76:79], v[108:111]
    ds_read_b64_tr_b16 v[148:149], v12 offset:31488
    ds_read_b64_tr_b16 v[150:151], v12 offset:32768
    s_waitcnt lgkmcnt(14)
    v_mfma_f32_16x16x32_bf16 v[112:115], v[152:155], v[76:79], v[112:115]
    ds_read_b64_tr_b16 v[152:153], v12 offset:31744
    ds_read_b64_tr_b16 v[154:155], v12 offset:33024
    s_waitcnt vmcnt(6)
    v_mfma_f32_16x16x32_bf16 v[96:99], v[116:119], v[80:83], v[96:99]
    ds_read_b64_tr_b16 v[116:117], v12 offset:35840
    ds_read_b64_tr_b16 v[118:119], v12 offset:37120
    v_mfma_f32_16x16x32_bf16 v[100:103], v[120:123], v[80:83], v[100:103]
    ds_read_b64_tr_b16 v[120:121], v12 offset:36096
    ds_read_b64_tr_b16 v[122:123], v12 offset:37376
    s_waitcnt lgkmcnt(14)
    v_mfma_f32_16x16x32_bf16 v[104:107], v[124:127], v[80:83], v[104:107]
    ds_read_b64_tr_b16 v[124:125], v12 offset:36352
    ds_read_b64_tr_b16 v[126:127], v12 offset:37632
    v_mfma_f32_16x16x32_bf16 v[108:111], v[128:131], v[80:83], v[108:111]
    ds_read_b64_tr_b16 v[128:129], v12 offset:36608
    ds_read_b64_tr_b16 v[130:131], v12 offset:37888
    v_mfma_f32_16x16x32_bf16 v[112:115], v[132:135], v[80:83], v[112:115]
    ds_read_b64_tr_b16 v[132:133], v12 offset:36864
    ds_read_b64_tr_b16 v[134:135], v12 offset:38144
    s_waitcnt vmcnt(4)
    s_waitcnt lgkmcnt(14)
    v_mfma_f32_16x16x32_bf16 v[96:99], v[136:139], v[84:87], v[96:99]
    ds_read_b64_tr_b16 v[136:137], v12 offset:40960
    ds_read_b64_tr_b16 v[138:139], v12 offset:42240
    v_mfma_f32_16x16x32_bf16 v[100:103], v[140:143], v[84:87], v[100:103]
    ds_read_b64_tr_b16 v[140:141], v12 offset:41216
    ds_read_b64_tr_b16 v[142:143], v12 offset:42496
    v_mfma_f32_16x16x32_bf16 v[104:107], v[144:147], v[84:87], v[104:107]
    ds_read_b64_tr_b16 v[144:145], v12 offset:41472
    ds_read_b64_tr_b16 v[146:147], v12 offset:42752
    s_waitcnt lgkmcnt(14)
    v_mfma_f32_16x16x32_bf16 v[108:111], v[148:151], v[84:87], v[108:111]
    ds_read_b64_tr_b16 v[148:149], v12 offset:41728
    ds_read_b64_tr_b16 v[150:151], v12 offset:43008
    v_mfma_f32_16x16x32_bf16 v[112:115], v[152:155], v[84:87], v[112:115]
    ds_read_b64_tr_b16 v[152:153], v12 offset:41984
    ds_read_b64_tr_b16 v[154:155], v12 offset:43264
    s_waitcnt vmcnt(2)
    v_mfma_f32_16x16x32_bf16 v[96:99], v[116:119], v[88:91], v[96:99]
    s_waitcnt lgkmcnt(14)
    v_mfma_f32_16x16x32_bf16 v[100:103], v[120:123], v[88:91], v[100:103]
    v_mfma_f32_16x16x32_bf16 v[104:107], v[124:127], v[88:91], v[104:107]
    s_waitcnt lgkmcnt(12)
    v_mfma_f32_16x16x32_bf16 v[108:111], v[128:131], v[88:91], v[108:111]
    s_waitcnt lgkmcnt(10)
    v_mfma_f32_16x16x32_bf16 v[112:115], v[132:135], v[88:91], v[112:115]
    s_waitcnt vmcnt(0)
    s_waitcnt lgkmcnt(8)
    v_mfma_f32_16x16x32_bf16 v[96:99], v[136:139], v[92:95], v[96:99]
    s_waitcnt lgkmcnt(6)
    v_mfma_f32_16x16x32_bf16 v[100:103], v[140:143], v[92:95], v[100:103]
    s_waitcnt lgkmcnt(4)
    v_mfma_f32_16x16x32_bf16 v[104:107], v[144:147], v[92:95], v[104:107]
    s_waitcnt lgkmcnt(2)
    v_mfma_f32_16x16x32_bf16 v[108:111], v[148:151], v[92:95], v[108:111]
    s_waitcnt lgkmcnt(0)
    v_mfma_f32_16x16x32_bf16 v[112:115], v[152:155], v[92:95], v[112:115]
    s_nop 7
    s_nop 3
    v_cvt_pk_bf16_f32 v116, v96, v97
    v_cvt_pk_bf16_f32 v117, v98, v99
    buffer_store_dwordx2 v[116:117], v13, s[16:19], s32 offen offset:0
    v_cvt_pk_bf16_f32 v118, v100, v101
    v_cvt_pk_bf16_f32 v119, v102, v103
    buffer_store_dwordx2 v[118:119], v13, s[16:19], s32 offen offset:32
    v_cvt_pk_bf16_f32 v120, v104, v105
    v_cvt_pk_bf16_f32 v121, v106, v107
    buffer_store_dwordx2 v[120:121], v13, s[16:19], s32 offen offset:64
    v_cvt_pk_bf16_f32 v122, v108, v109
    v_cvt_pk_bf16_f32 v123, v110, v111
    buffer_store_dwordx2 v[122:123], v13, s[16:19], s32 offen offset:96
    v_cvt_pk_bf16_f32 v124, v112, v113
    v_cvt_pk_bf16_f32 v125, v114, v115
    buffer_store_dwordx2 v[124:125], v13, s[16:19], s32 offen offset:128
    s_endpgm
L_aux:
    v_lshlrev_b32 v8, 4, v1
    s_mov_b32 s80, s58
    s_mov_b32 s81, s59
    s_mov_b32 s82, 25600
    s_mov_b32 s83, 0x20000
    s_mov_b32 s84, s60
    s_mov_b32 s85, s61
    s_mov_b32 s86, 25600
    s_mov_b32 s87, 0x20000
    s_cmp_eq_u32 s13, 0
    s_cbranch_scc1 L_e0
    s_add_u32 s5, s94, 0
    s_cmp_ge_u32 s5, 10
    s_cselect_b32 s4, 10, 0
    s_sub_u32 s5, s5, s4
    s_mul_i32 s5, s5, 2560
    s_mov_b32 m0, 26624
    s_nop 0
    buffer_load_dwordx4 v8, s[80:83], s5 offen offset:0 lds
    buffer_load_dwordx4 v8, s[80:83], s5 offen offset:1024 lds
    buffer_load_dwordx4 v8, s[80:83], s5 offen offset:2048 lds
    s_mov_b32 m0, 29696
    s_nop 0
    buffer_load_dwordx4 v8, s[84:87], s5 offen offset:0 lds
    buffer_load_dwordx4 v8, s[84:87], s5 offen offset:1024 lds
    buffer_load_dwordx4 v8, s[84:87], s5 offen offset:2048 lds
L_e0:
    s_cmp_eq_u32 s13, 0
    s_cbranch_scc1 L_e1
    s_add_u32 s5, s94, 1
    s_cmp_ge_u32 s5, 10
    s_cselect_b32 s4, 10, 0
    s_sub_u32 s5, s5, s4
    s_mul_i32 s5, s5, 2560
    s_mov_b32 m0, 59392
    s_nop 0
    buffer_load_dwordx4 v8, s[80:83], s5 offen offset:0 lds
    buffer_load_dwordx4 v8, s[80:83], s5 offen offset:1024 lds
    buffer_load_dwordx4 v8, s[80:83], s5 offen offset:2048 lds
    s_mov_b32 m0, 62464
    s_nop 0
    buffer_load_dwordx4 v8, s[84:87], s5 offen offset:0 lds
    buffer_load_dwordx4 v8, s[84:87], s5 offen offset:1024 lds
    buffer_load_dwordx4 v8, s[84:87], s5 offen offset:2048 lds
L_e1:
    s_cmp_eq_u32 s13, 0
    s_cbranch_scc1 L_e2
    s_add_u32 s5, s94, 2
    s_cmp_ge_u32 s5, 10
    s_cselect_b32 s4, 10, 0
    s_sub_u32 s5, s5, s4
    s_mul_i32 s5, s5, 2560
    s_mov_b32 m0, 92160
    s_nop 0
    buffer_load_dwordx4 v8, s[80:83], s5 offen offset:0 lds
    buffer_load_dwordx4 v8, s[80:83], s5 offen offset:1024 lds
    buffer_load_dwordx4 v8, s[80:83], s5 offen offset:2048 lds
    s_mov_b32 m0, 95232
    s_nop 0
    buffer_load_dwordx4 v8, s[84:87], s5 offen offset:0 lds
    buffer_load_dwordx4 v8, s[84:87], s5 offen offset:1024 lds
    buffer_load_dwordx4 v8, s[84:87], s5 offen offset:2048 lds
L_e2:
    s_cmp_eq_u32 s13, 0
    s_cbranch_scc1 L_e3
    s_add_u32 s5, s94, 3
    s_cmp_ge_u32 s5, 10
    s_cselect_b32 s4, 10, 0
    s_sub_u32 s5, s5, s4
    s_mul_i32 s5, s5, 2560
    s_mov_b32 m0, 124928
    s_nop 0
    buffer_load_dwordx4 v8, s[80:83], s5 offen offset:0 lds
    buffer_load_dwordx4 v8, s[80:83], s5 offen offset:1024 lds
    buffer_load_dwordx4 v8, s[80:83], s5 offen offset:2048 lds
    s_mov_b32 m0, 128000
    s_nop 0
    buffer_load_dwordx4 v8, s[84:87], s5 offen offset:0 lds
    buffer_load_dwordx4 v8, s[84:87], s5 offen offset:1024 lds
    buffer_load_dwordx4 v8, s[84:87], s5 offen offset:2048 lds
L_e3:
    s_setprio 3
    v_mov_b32 v4, 0
    v_mov_b32 v5, 1
    s_cmp_ge_u32 s2, 72
    s_cbranch_scc1 L_aux_noinit
    s_lshl_b32 s3, s2, 8
    s_add_u32 s3, s3, 17563648
    s_mov_b64 exec, 1
    buffer_store_dword v4, v4, s[8:11], s3 offen sc1
    s_waitcnt vmcnt(0)
    buffer_atomic_add v5, v4, s[28:31], 0 offen sc1
    s_mov_b64 exec, -1
L_aux_noinit:
    v_add_u32 v4, 0, v1
    v_mul_u32_u24 v5, 3277, v4
    v_lshrrev_b32 v5, 18, v5
    v_mul_u32_u24 v6, 80, v5
    v_sub_u32 v6, v4, v6
    v_mul_u32_u24 v5, 3328, v5
    v_lshl_add_u32 v32, v6, 4, v5
    v_cmp_le_u32 vcc, 64, v6
    v_mov_b32 v7, 2048
    v_mul_u32_u24 v5, 205, v6
    v_cndmask_b32 v7, 0, v7, vcc
    v_lshrrev_b32 v5, 12, v5
    v_mul_u32_u24 v5, 192, v5
    v_add_u32 v5, 1024, v5
    s_cmp_ge_u32 s32, 8
    s_cselect_b64 vcc, -1, 0
    v_cndmask_b32 v7, v7, v5, vcc
    v_add_u32 v32, v32, v7
    v_add_u32 v4, 64, v1
    v_mul_u32_u24 v5, 3277, v4
    v_lshrrev_b32 v5, 18, v5
    v_mul_u32_u24 v6, 80, v5
    v_sub_u32 v6, v4, v6
    v_mul_u32_u24 v5, 3328, v5
    v_lshl_add_u32 v33, v6, 4, v5
    v_cmp_le_u32 vcc, 64, v6
    v_mov_b32 v7, 2048
    v_mul_u32_u24 v5, 205, v6
    v_cndmask_b32 v7, 0, v7, vcc
    v_lshrrev_b32 v5, 12, v5
    v_mul_u32_u24 v5, 192, v5
    v_add_u32 v5, 1024, v5
    s_cmp_ge_u32 s32, 8
    s_cselect_b64 vcc, -1, 0
    v_cndmask_b32 v7, v7, v5, vcc
    v_add_u32 v33, v33, v7
    v_add_u32 v4, 128, v1
    v_mul_u32_u24 v5, 3277, v4
    v_lshrrev_b32 v5, 18, v5
    v_mul_u32_u24 v6, 80, v5
    v_sub_u32 v6, v4, v6
    v_mul_u32_u24 v5, 3328, v5
    v_lshl_add_u32 v34, v6, 4, v5
    v_cmp_le_u32 vcc, 64, v6
    v_mov_b32 v7, 2048
    v_mul_u32_u24 v5, 205, v6
    v_cndmask_b32 v7, 0, v7, vcc
    v_lshrrev_b32 v5, 12, v5
    v_mul_u32_u24 v5, 192, v5
    v_add_u32 v5, 1024, v5
    s_cmp_ge_u32 s32, 8
    s_cselect_b64 vcc, -1, 0
    v_cndmask_b32 v7, v7, v5, vcc
    v_add_u32 v34, v34, v7
    v_add_u32 v4, 192, v1
    v_mul_u32_u24 v5, 3277, v4
    v_lshrrev_b32 v5, 18, v5
    v_mul_u32_u24 v6, 80, v5
    v_sub_u32 v6, v4, v6
    v_mul_u32_u24 v5, 3328, v5
    v_lshl_add_u32 v35, v6, 4, v5
    v_cmp_le_u32 vcc, 64, v6
    v_mov_b32 v7, 2048
    v_mul_u32_u24 v5, 205, v6
    v_cndmask_b32 v7, 0, v7, vcc
    v_lshrrev_b32 v5, 12, v5
    v_mul_u32_u24 v5, 192, v5
    v_add_u32 v5, 1024, v5
    s_cmp_ge_u32 s32, 8
    s_cselect_b64 vcc, -1, 0
    v_cndmask_b32 v7, v7, v5, vcc
    v_add_u32 v35, v35, v7
    v_add_u32 v4, 256, v1
    v_mul_u32_u24 v5, 3277, v4
    v_lshrrev_b32 v5, 18, v5
    v_mul_u32_u24 v6, 80, v5
    v_sub_u32 v6, v4, v6
    v_mul_u32_u24 v5, 3328, v5
    v_lshl_add_u32 v36, v6, 4, v5
    v_cmp_le_u32 vcc, 64, v6
    v_mov_b32 v7, 2048
    v_mul_u32_u24 v5, 205, v6
    v_cndmask_b32 v7, 0, v7, vcc
    v_lshrrev_b32 v5, 12, v5
    v_mul_u32_u24 v5, 192, v5
    v_add_u32 v5, 1024, v5
    s_cmp_ge_u32 s32, 8
    s_cselect_b64 vcc, -1, 0
    v_cndmask_b32 v7, v7, v5, vcc
    v_add_u32 v36, v36, v7
    s_mul_i32 s7, s14, 160
    v_add_u32 v4, 0, v3
    v_mul_u32_u24 v5, 205, v4
    v_lshrrev_b32 v5, 10, v5
    v_mul_u32_u24 v6, 5, v5
    v_sub_u32 v4, v4, v6
    v_lshlrev_b32 v4, 5, v4
    v_and_b32 v6, 1, v1
    v_lshl_add_u32 v4, v6, 4, v4
    v_add_u32 v4, s7, v4
    v_bfe_u32 v6, v1, 1, 2
    v_bfe_u32 v7, v1, 3, 1
    v_lshrrev_b32 v14, 1, v5
    v_mul_u32_u24 v14, 20, v14
    v_lshl_add_u32 v14, v7, 3, v14
    v_and_b32 v19, 1, v5
    v_lshl_add_u32 v14, v19, 2, v14
    v_add_u32 v14, v14, v6
    v_mul_u32_u24 v14, 1280, v14
    v_add_u32 v14, v14, v4
    v_lshrrev_b32 v5, 1, v5
    v_lshl_add_u32 v5, v5, 1, v7
    v_lshl_add_u32 v19, v5, 1, v19
    v_mul_u32_u24 v19, 20, v19
    v_add3_u32 v19, v19, v6, 16
    v_mul_u32_u24 v19, 1280, v19
    v_add_u32 v19, v19, v4
    v_add_u32 v4, 4, v3
    v_mul_u32_u24 v5, 205, v4
    v_lshrrev_b32 v5, 10, v5
    v_mul_u32_u24 v6, 5, v5
    v_sub_u32 v4, v4, v6
    v_lshlrev_b32 v4, 5, v4
    v_and_b32 v6, 1, v1
    v_lshl_add_u32 v4, v6, 4, v4
    v_add_u32 v4, s7, v4
    v_bfe_u32 v6, v1, 1, 2
    v_bfe_u32 v7, v1, 3, 1
    v_lshrrev_b32 v15, 1, v5
    v_mul_u32_u24 v15, 20, v15
    v_lshl_add_u32 v15, v7, 3, v15
    v_and_b32 v20, 1, v5
    v_lshl_add_u32 v15, v20, 2, v15
    v_add_u32 v15, v15, v6
    v_mul_u32_u24 v15, 1280, v15
    v_add_u32 v15, v15, v4
    v_lshrrev_b32 v5, 1, v5
    v_lshl_add_u32 v5, v5, 1, v7
    v_lshl_add_u32 v20, v5, 1, v20
    v_mul_u32_u24 v20, 20, v20
    v_add3_u32 v20, v20, v6, 16
    v_mul_u32_u24 v20, 1280, v20
    v_add_u32 v20, v20, v4
    v_add_u32 v4, 8, v3
    v_mul_u32_u24 v5, 205, v4
    v_lshrrev_b32 v5, 10, v5
    v_mul_u32_u24 v6, 5, v5
    v_sub_u32 v4, v4, v6
    v_lshlrev_b32 v4, 5, v4
    v_and_b32 v6, 1, v1
    v_lshl_add_u32 v4, v6, 4, v4
    v_add_u32 v4, s7, v4
    v_bfe_u32 v6, v1, 1, 2
    v_bfe_u32 v7, v1, 3, 1
    v_lshrrev_b32 v16, 1, v5
    v_mul_u32_u24 v16, 20, v16
    v_lshl_add_u32 v16, v7, 3, v16
    v_and_b32 v21, 1, v5
    v_lshl_add_u32 v16, v21, 2, v16
    v_add_u32 v16, v16, v6
    v_mul_u32_u24 v16, 1280, v16
    v_add_u32 v16, v16, v4
    v_lshrrev_b32 v5, 1, v5
    v_lshl_add_u32 v5, v5, 1, v7
    v_lshl_add_u32 v21, v5, 1, v21
    v_mul_u32_u24 v21, 20, v21
    v_add3_u32 v21, v21, v6, 16
    v_mul_u32_u24 v21, 1280, v21
    v_add_u32 v21, v21, v4
    v_add_u32 v4, 12, v3
    v_mul_u32_u24 v5, 205, v4
    v_lshrrev_b32 v5, 10, v5
    v_mul_u32_u24 v6, 5, v5
    v_sub_u32 v4, v4, v6
    v_lshlrev_b32 v4, 5, v4
    v_and_b32 v6, 1, v1
    v_lshl_add_u32 v4, v6, 4, v4
    v_add_u32 v4, s7, v4
    v_bfe_u32 v6, v1, 1, 2
    v_bfe_u32 v7, v1, 3, 1
    v_lshrrev_b32 v17, 1, v5
    v_mul_u32_u24 v17, 20, v17
    v_lshl_add_u32 v17, v7, 3, v17
    v_and_b32 v22, 1, v5
    v_lshl_add_u32 v17, v22, 2, v17
    v_add_u32 v17, v17, v6
    v_mul_u32_u24 v17, 1280, v17
    v_add_u32 v17, v17, v4
    v_lshrrev_b32 v5, 1, v5
    v_lshl_add_u32 v5, v5, 1, v7
    v_lshl_add_u32 v22, v5, 1, v22
    v_mul_u32_u24 v22, 20, v22
    v_add3_u32 v22, v22, v6, 16
    v_mul_u32_u24 v22, 1280, v22
    v_add_u32 v22, v22, v4
    v_add_u32 v4, 16, v3
    v_mul_u32_u24 v5, 205, v4
    v_lshrrev_b32 v5, 10, v5
    v_mul_u32_u24 v6, 5, v5
    v_sub_u32 v4, v4, v6
    v_lshlrev_b32 v4, 5, v4
    v_and_b32 v6, 1, v1
    v_lshl_add_u32 v4, v6, 4, v4
    v_add_u32 v4, s7, v4
    v_bfe_u32 v6, v1, 1, 2
    v_bfe_u32 v7, v1, 3, 1
    v_lshrrev_b32 v18, 1, v5
    v_mul_u32_u24 v18, 20, v18
    v_lshl_add_u32 v18, v7, 3, v18
    v_and_b32 v23, 1, v5
    v_lshl_add_u32 v18, v23, 2, v18
    v_add_u32 v18, v18, v6
    v_mul_u32_u24 v18, 1280, v18
    v_add_u32 v18, v18, v4
    v_lshrrev_b32 v5, 1, v5
    v_lshl_add_u32 v5, v5, 1, v7
    v_lshl_add_u32 v23, v5, 1, v23
    v_mul_u32_u24 v23, 20, v23
    v_add3_u32 v23, v23, v6, 16
    v_mul_u32_u24 v23, 1280, v23
    v_add_u32 v23, v23, v4
    s_and_b32 s3, s32, 7
    s_lshl_b32 s3, s3, 8
    s_lshl_b32 s4, s33, 2
    s_add_u32 s3, s3, s4
    s_mul_i32 s26, s3, 3328
    s_add_u32 s26, s26, 10485760
    v_lshlrev_b32 v8, 4, v1
    v_add_u32 v11, 131072, v8
    v_mov_b32 v39, 0
    s_waitcnt vmcnt(18)
    s_barrier
    s_waitcnt vmcnt(12)
    s_barrier
    s_cmp_eq_u32 s13, 0
    s_cbranch_scc1 L_e4
    s_add_u32 s5, s94, 4
    s_cmp_ge_u32 s5, 10
    s_cselect_b32 s4, 10, 0
    s_sub_u32 s5, s5, s4
    s_mul_i32 s5, s5, 2560
    s_mov_b32 m0, 26624
    s_nop 0
    buffer_load_dwordx4 v8, s[80:83], s5 offen offset:0 lds
    buffer_load_dwordx4 v8, s[80:83], s5 offen offset:1024 lds
    buffer_load_dwordx4 v8, s[80:83], s5 offen offset:2048 lds
    s_mov_b32 m0, 29696
    s_nop 0
    buffer_load_dwordx4 v8, s[84:87], s5 offen offset:0 lds
    buffer_load_dwordx4 v8, s[84:87], s5 offen offset:1024 lds
    buffer_load_dwordx4 v8, s[84:87], s5 offen offset:2048 lds
L_e4:
    s_waitcnt vmcnt(12)
    s_barrier
    s_cmp_eq_u32 s13, 0
    s_cbranch_scc1 L_e5
    s_add_u32 s5, s94, 5
    s_cmp_ge_u32 s5, 10
    s_cselect_b32 s4, 10, 0
    s_sub_u32 s5, s5, s4
    s_mul_i32 s5, s5, 2560
    s_mov_b32 m0, 59392
    s_nop 0
    buffer_load_dwordx4 v8, s[80:83], s5 offen offset:0 lds
    buffer_load_dwordx4 v8, s[80:83], s5 offen offset:1024 lds
    buffer_load_dwordx4 v8, s[80:83], s5 offen offset:2048 lds
    s_mov_b32 m0, 62464
    s_nop 0
    buffer_load_dwordx4 v8, s[84:87], s5 offen offset:0 lds
    buffer_load_dwordx4 v8, s[84:87], s5 offen offset:1024 lds
    buffer_load_dwordx4 v8, s[84:87], s5 offen offset:2048 lds
L_e5:
    s_waitcnt vmcnt(12)
    s_barrier
    s_cmp_eq_u32 s13, 0
    s_cbranch_scc1 L_e6
    s_add_u32 s5, s94, 6
    s_cmp_ge_u32 s5, 10
    s_cselect_b32 s4, 10, 0
    s_sub_u32 s5, s5, s4
    s_mul_i32 s5, s5, 2560
    s_mov_b32 m0, 92160
    s_nop 0
    buffer_load_dwordx4 v8, s[80:83], s5 offen offset:0 lds
    buffer_load_dwordx4 v8, s[80:83], s5 offen offset:1024 lds
    buffer_load_dwordx4 v8, s[80:83], s5 offen offset:2048 lds
    s_mov_b32 m0, 95232
    s_nop 0
    buffer_load_dwordx4 v8, s[84:87], s5 offen offset:0 lds
    buffer_load_dwordx4 v8, s[84:87], s5 offen offset:1024 lds
    buffer_load_dwordx4 v8, s[84:87], s5 offen offset:2048 lds
L_e6:
    s_waitcnt vmcnt(12)
    s_barrier
    s_cmp_eq_u32 s13, 0
    s_cbranch_scc1 L_e7
    s_add_u32 s5, s94, 7
    s_cmp_ge_u32 s5, 10
    s_cselect_b32 s4, 10, 0
    s_sub_u32 s5, s5, s4
    s_mul_i32 s5, s5, 2560
    s_mov_b32 m0, 124928
    s_nop 0
    buffer_load_dwordx4 v8, s[80:83], s5 offen offset:0 lds
    buffer_load_dwordx4 v8, s[80:83], s5 offen offset:1024 lds
    buffer_load_dwordx4 v8, s[80:83], s5 offen offset:2048 lds
    s_mov_b32 m0, 128000
    s_nop 0
    buffer_load_dwordx4 v8, s[84:87], s5 offen offset:0 lds
    buffer_load_dwordx4 v8, s[84:87], s5 offen offset:1024 lds
    buffer_load_dwordx4 v8, s[84:87], s5 offen offset:2048 lds
L_e7:
    s_waitcnt vmcnt(12)
    s_barrier
    s_cmp_eq_u32 s13, 0
    s_cbranch_scc1 L_e8
    s_add_u32 s5, s94, 8
    s_cmp_ge_u32 s5, 10
    s_cselect_b32 s4, 10, 0
    s_sub_u32 s5, s5, s4
    s_mul_i32 s5, s5, 2560
    s_mov_b32 m0, 26624
    s_nop 0
    buffer_load_dwordx4 v8, s[80:83], s5 offen offset:0 lds
    buffer_load_dwordx4 v8, s[80:83], s5 offen offset:1024 lds
    buffer_load_dwordx4 v8, s[80:83], s5 offen offset:2048 lds
    s_mov_b32 m0, 29696
    s_nop 0
    buffer_load_dwordx4 v8, s[84:87], s5 offen offset:0 lds
    buffer_load_dwordx4 v8, s[84:87], s5 offen offset:1024 lds
    buffer_load_dwordx4 v8, s[84:87], s5 offen offset:2048 lds
L_e8:
    buffer_load_dword v40, v39, s[28:31], 0 offen sc1
    s_waitcnt vmcnt(13)
    s_barrier
    s_cmp_eq_u32 s13, 0
    s_cbranch_scc1 L_e9
    s_add_u32 s5, s94, 9
    s_cmp_ge_u32 s5, 10
    s_cselect_b32 s4, 10, 0
    s_sub_u32 s5, s5, s4
    s_mul_i32 s5, s5, 2560
    s_mov_b32 m0, 59392
    s_nop 0
    buffer_load_dwordx4 v8, s[80:83], s5 offen offset:0 lds
    buffer_load_dwordx4 v8, s[80:83], s5 offen offset:1024 lds
    buffer_load_dwordx4 v8, s[80:83], s5 offen offset:2048 lds
    s_mov_b32 m0, 62464
    s_nop 0
    buffer_load_dwordx4 v8, s[84:87], s5 offen offset:0 lds
    buffer_load_dwordx4 v8, s[84:87], s5 offen offset:1024 lds
    buffer_load_dwordx4 v8, s[84:87], s5 offen offset:2048 lds
L_e9:
    s_waitcnt vmcnt(13)
    s_barrier
    s_waitcnt vmcnt(7)
    s_barrier
    s_waitcnt vmcnt(0)
    s_barrier
    s_mov_b32 s4, 0
    s_waitcnt vmcnt(0)
L_aux_chk:
    v_cmp_ne_u32 vcc, 72, v40
    s_add_u32 s4, s4, 1
    s_cmp_gt_u32 s4, 60000
    s_cbranch_scc1 L_aux_chkt
    s_cbranch_vccz L_aux_chkd
    s_sleep 4
    buffer_load_dword v40, v39, s[28:31], 0 offen sc1
    s_waitcnt vmcnt(0)
    s_branch L_aux_chk
L_aux_chkt:
L_aux_chkd:
    s_barrier
    s_cmp_eq_u32 s13, 0
    s_cbranch_scc0 L_aux_ex
    ds_read_b128 v[56:59], v11 offset:0
    ds_read_b128 v[60:63], v11 offset:1024
    ds_read_b128 v[64:67], v11 offset:2048
    ds_read_b128 v[68:71], v11 offset:3072
    ds_read_b128 v[72:75], v11 offset:4096
    ds_read_b128 v[76:79], v11 offset:5120
    ds_read_b128 v[80:83], v11 offset:6144
    ds_read_b128 v[84:87], v11 offset:7168
    ds_read_b128 v[88:91], v11 offset:8192
    ds_read_b128 v[92:95], v11 offset:9216
    s_waitcnt lgkmcnt(9)
    s_add_u32 s6, s26, 0
    buffer_store_dwordx4 v[56:59], v32, s[8:11], s6 offen sc1
    s_waitcnt lgkmcnt(8)
    buffer_store_dwordx4 v[60:63], v33, s[8:11], s6 offen sc1
    s_waitcnt lgkmcnt(7)
    buffer_store_dwordx4 v[64:67], v34, s[8:11], s6 offen sc1
    s_waitcnt lgkmcnt(6)
    buffer_store_dwordx4 v[68:71], v35, s[8:11], s6 offen sc1
    s_waitcnt lgkmcnt(5)
    buffer_store_dwordx4 v[72:75], v36, s[8:11], s6 offen sc1
    s_waitcnt lgkmcnt(4)
    s_add_u32 s6, s26, 212992
    buffer_store_dwordx4 v[76:79], v32, s[8:11], s6 offen sc1
    s_waitcnt lgkmcnt(3)
    buffer_store_dwordx4 v[80:83], v33, s[8:11], s6 offen sc1
    s_waitcnt lgkmcnt(2)
    buffer_store_dwordx4 v[84:87], v34, s[8:11], s6 offen sc1
    s_waitcnt lgkmcnt(1)
    buffer_store_dwordx4 v[88:91], v35, s[8:11], s6 offen sc1
    s_waitcnt lgkmcnt(0)
    buffer_store_dwordx4 v[92:95], v36, s[8:11], s6 offen sc1
    s_barrier
    ds_read_b128 v[96:99], v11 offset:10240
    ds_read_b128 v[100:103], v11 offset:11264
    ds_read_b128 v[104:107], v11 offset:12288
    ds_read_b128 v[108:111], v11 offset:13312
    ds_read_b128 v[112:115], v11 offset:14336
    ds_read_b128 v[116:119], v11 offset:15360
    ds_read_b128 v[120:123], v11 offset:16384
    ds_read_b128 v[124:127], v11 offset:17408
    ds_read_b128 v[128:131], v11 offset:18432
    ds_read_b128 v[132:135], v11 offset:19456
    s_waitcnt lgkmcnt(9)
    s_add_u32 s6, s26, 425984
    buffer_store_dwordx4 v[96:99], v32, s[8:11], s6 offen sc1
    s_waitcnt lgkmcnt(8)
    buffer_store_dwordx4 v[100:103], v33, s[8:11], s6 offen sc1
    s_waitcnt lgkmcnt(7)
    buffer_store_dwordx4 v[104:107], v34, s[8:11], s6 offen sc1
    s_waitcnt lgkmcnt(6)
    buffer_store_dwordx4 v[108:111], v35, s[8:11], s6 offen sc1
    s_waitcnt lgkmcnt(5)
    buffer_store_dwordx4 v[112:115], v36, s[8:11], s6 offen sc1
    s_waitcnt lgkmcnt(4)
    s_add_u32 s6, s26, 638976
    buffer_store_dwordx4 v[116:119], v32, s[8:11], s6 offen sc1
    s_waitcnt lgkmcnt(3)
    buffer_store_dwordx4 v[120:123], v33, s[8:11], s6 offen sc1
    s_waitcnt lgkmcnt(2)
    buffer_store_dwordx4 v[124:127], v34, s[8:11], s6 offen sc1
    s_waitcnt lgkmcnt(1)
    buffer_store_dwordx4 v[128:131], v35, s[8:11], s6 offen sc1
    s_waitcnt lgkmcnt(0)
    buffer_store_dwordx4 v[132:135], v36, s[8:11], s6 offen sc1
    s_barrier
    s_mov_b32 s4, s32
    s_branch L_aux_sig0
L_aux_ex:
    v_and_b32 v6, 3, v2
    v_bfe_u32 v7, v2, 2, 1
    v_lshl_add_u32 v6, v7, 3, v6
    v_bfe_u32 v7, v2, 3, 1
    v_lshl_add_u32 v6, v7, 2, v6
    v_lshlrev_b32 v4, 3, v1
    v_add_u32 v4, 151552, v4
    ds_read_b64 v[56:57], v4
    ds_read_b64 v[58:59], v4 offset:512
    ds_read_b64 v[60:61], v4 offset:1024
    ds_read_b64 v[62:63], v4 offset:1536
    s_lshl_b32 s3, s15, 2
    s_lshr_b32 s4, s14, 1
    s_add_u32 s3, s3, s4
    s_mul_i32 s6, s3, 3328
    s_add_u32 s6, s6, 17301504
    s_and_b32 s4, s14, 1
    s_lshl_b32 s5, s4, 4
    v_add_u32 v6, s5, v6
    v_lshrrev_b32 v7, 1, v3
    v_lshl_add_u32 v7, v7, 5, v6
    v_lshlrev_b32 v7, 4, v7
    v_and_b32 v4, 1, v3
    v_lshl_add_u32 v64, v4, 3, v7
    v_lshlrev_b32 v65, 3, v6
    v_lshrrev_b32 v7, 1, v3
    v_lshlrev_b32 v7, 9, v7
    v_lshl_add_u32 v7, v4, 3, v7
    s_lshl_b32 s4, s4, 10
    v_add_u32 v7, s4, v7
    v_lshl_add_u32 v66, v2, 4, v7
    s_waitcnt lgkmcnt(0)
    buffer_store_dwordx2 v[56:57], v64, s[8:11], s6 offen sc1
    buffer_store_dwordx2 v[60:61], v66, s[8:11], s6 offen offset:1024 sc1
    s_mov_b64 exec, 0xffff
    buffer_store_dwordx2 v[58:59], v65, s[8:11], s6 offen offset:3072 sc1
    s_mov_b32 exec_lo, 0x000f000f
    s_mov_b32 exec_hi, 0x000f000f
    buffer_store_dwordx2 v[62:63], v66, s[8:11], s6 offen offset:1280 sc1
    s_mov_b64 exec, -1
    s_barrier
    s_barrier
    s_lshr_b32 s4, s15, 1
    s_add_u32 s4, s4, 32
    s_waitcnt vmcnt(0)
    s_lshl_b32 s3, s4, 8
    s_add_u32 s3, s3, 17563648
    v_mov_b32 v4, 0
    v_mov_b32 v5, 1
    s_mov_b64 exec, 1
    buffer_atomic_add v5, v4, s[8:11], s3 offen sc1
    s_mov_b64 exec, -1
    s_barrier
    s_branch L_aux_sig1
L_aux_sig0:
    s_barrier
    s_waitcnt vmcnt(0)
    s_lshl_b32 s3, s4, 8
    s_add_u32 s3, s3, 17563648
    v_mov_b32 v4, 0
    v_mov_b32 v5, 1
    s_mov_b64 exec, 1
    buffer_atomic_add v5, v4, s[8:11], s3 offen sc1
    s_mov_b64 exec, -1
L_aux_sig1:
    s_cmp_eq_u32 s13, 0
    s_cselect_b32 s84, s52, s62
    s_cselect_b32 s85, s53, s63
    s_mov_b32 s86, 819200
    s_mov_b32 s87, 0x20000
    s_barrier
    s_lshl_b32 s3, s14, 2
    s_cmp_eq_u32 s13, 0
    s_cselect_b32 s3, s3, 32
    s_cselect_b32 s22, 4, 1
    s_mul_i32 s20, s3, 212992
    s_add_u32 s20, s20, 10485760
    v_lshlrev_b32 v8, 4, v1
    s_add_u32 s21, s20, 23296
    s_barrier
    s_barrier
    s_barrier
    s_barrier
    s_barrier
    s_barrier
    s_mov_b32 s25, 107008
    s_mul_i32 s24, s14, 102400
    s_mov_b32 s27, 93632
    s_mov_b32 s34, 0
    s_barrier
    s_cmp_eq_u32 s13, 0
    s_cbranch_scc0 L_pB
    s_barrier
    s_add_u32 m0, s27, 0
    s_mov_b64 exec, s[40:41]
    buffer_load_dwordx4 v8, s[8:11], s21 offen offset:1024 sc1 lds
    buffer_load_dwordx4 v8, s[8:11], s21 offen offset:2048 sc1 lds
    s_mov_b64 exec, s[42:43]
    buffer_load_dwordx4 v8, s[8:11], s21 offen offset:3072 sc1 lds
    s_mov_b64 exec, -1
    buffer_load_dwordx4 v8, s[8:11], s21 offen sc1 lds
    s_add_u32 s4, s21, 212992
    s_add_u32 m0, s27, 3344
    s_mov_b64 exec, s[40:41]
    buffer_load_dwordx4 v8, s[8:11], s4 offen offset:1024 sc1 lds
    buffer_load_dwordx4 v8, s[8:11], s4 offen offset:2048 sc1 lds
    s_mov_b64 exec, s[42:43]
    buffer_load_dwordx4 v8, s[8:11], s4 offen offset:3072 sc1 lds
    s_mov_b64 exec, -1
    buffer_load_dwordx4 v8, s[8:11], s4 offen sc1 lds
    s_add_u32 s4, s21, 425984
    s_add_u32 m0, s27, 6688
    s_mov_b64 exec, s[40:41]
    buffer_load_dwordx4 v8, s[8:11], s4 offen offset:1024 sc1 lds
    buffer_load_dwordx4 v8, s[8:11], s4 offen offset:2048 sc1 lds
    s_mov_b64 exec, s[42:43]
    buffer_load_dwordx4 v8, s[8:11], s4 offen offset:3072 sc1 lds
    s_mov_b64 exec, -1
    buffer_load_dwordx4 v8, s[8:11], s4 offen sc1 lds
    s_add_u32 s4, s21, 638976
    s_add_u32 m0, s27, 10032
    s_mov_b64 exec, s[40:41]
    buffer_load_dwordx4 v8, s[8:11], s4 offen offset:1024 sc1 lds
    buffer_load_dwordx4 v8, s[8:11], s4 offen offset:2048 sc1 lds
    s_mov_b64 exec, s[42:43]
    buffer_load_dwordx4 v8, s[8:11], s4 offen offset:3072 sc1 lds
    s_mov_b64 exec, -1
    buffer_load_dwordx4 v8, s[8:11], s4 offen sc1 lds
    s_add_u32 s21, s21, 3328
    s_add_u32 s27, s27, 13376
    s_cmp_eq_u32 s27, 107008
    s_cselect_b32 s27, 0, s27
    s_add_u32 m0, s27, 0
    s_mov_b64 exec, s[40:41]
    buffer_load_dwordx4 v8, s[8:11], s21 offen offset:1024 sc1 lds
    buffer_load_dwordx4 v8, s[8:11], s21 offen offset:2048 sc1 lds
    s_mov_b64 exec, s[42:43]
    buffer_load_dwordx4 v8, s[8:11], s21 offen offset:3072 sc1 lds
    s_mov_b64 exec, -1
    buffer_load_dwordx4 v8, s[8:11], s21 offen sc1 lds
    s_add_u32 s4, s21, 212992
    s_add_u32 m0, s27, 3344
    s_mov_b64 exec, s[40:41]
    buffer_load_dwordx4 v8, s[8:11], s4 offen offset:1024 sc1 lds
    buffer_load_dwordx4 v8, s[8:11], s4 offen offset:2048 sc1 lds
    s_mov_b64 exec, s[42:43]
    buffer_load_dwordx4 v8, s[8:11], s4 offen offset:3072 sc1 lds
    s_mov_b64 exec, -1
    buffer_load_dwordx4 v8, s[8:11], s4 offen sc1 lds
    s_add_u32 s4, s21, 425984
    s_add_u32 m0, s27, 6688
    s_mov_b64 exec, s[40:41]
    buffer_load_dwordx4 v8, s[8:11], s4 offen offset:1024 sc1 lds
    buffer_load_dwordx4 v8, s[8:11], s4 offen offset:2048 sc1 lds
    s_mov_b64 exec, s[42:43]
    buffer_load_dwordx4 v8, s[8:11], s4 offen offset:3072 sc1 lds
    s_mov_b64 exec, -1
    buffer_load_dwordx4 v8, s[8:11], s4 offen sc1 lds
    s_add_u32 s4, s21, 638976
    s_add_u32 m0, s27, 10032
    s_mov_b64 exec, s[40:41]
    buffer_load_dwordx4 v8, s[8:11], s4 offen offset:1024 sc1 lds
    buffer_load_dwordx4 v8, s[8:11], s4 offen offset:2048 sc1 lds
    s_mov_b64 exec, s[42:43]
    buffer_load_dwordx4 v8, s[8:11], s4 offen offset:3072 sc1 lds
    s_mov_b64 exec, -1
    buffer_load_dwordx4 v8, s[8:11], s4 offen sc1 lds
    s_add_u32 s21, s21, 3328
    s_add_u32 s27, s27, 13376
    s_cmp_eq_u32 s27, 107008
    s_cselect_b32 s27, 0, s27
    v_and_b32 v6, 1, v1
    v_lshlrev_b32 v6, 3, v6
    v_add_u32 v6, s14, v6
    v_add_u32 v6, 16, v6
    v_lshlrev_b32 v6, 8, v6
    v_add_u32 v6, 17563648, v6
    s_mov_b32 s34, 1
L_pA_w:
    s_waitcnt vmcnt(32)
    s_barrier
    s_cmp_lg_u32 s34, 11
    s_cbranch_scc1 L_pA_h
    s_mov_b64 exec, 3
    s_mov_b32 s3, 0
L_pA_late:
    buffer_load_dword v7, v6, s[8:11], 0 offen sc1
    s_waitcnt vmcnt(0)
    v_cmp_ne_u32 vcc, 8, v7
    s_add_u32 s3, s3, 1
    s_cmp_gt_u32 s3, 60000
    s_cbranch_scc1 L_pA_late_t
    s_cbranch_vccz L_pA_late_d
    s_sleep 2
    s_branch L_pA_late
L_pA_late_t:
L_pA_late_d:
    s_mov_b64 exec, -1
L_pA_h:
    s_add_u32 m0, s25, 0
    s_nop 0
    buffer_load_dwordx4 v14, s[84:87], s24 offen lds
    s_add_u32 m0, s25, 1024
    s_nop 0
    buffer_load_dwordx4 v15, s[84:87], s24 offen lds
    s_add_u32 m0, s25, 2048
    s_nop 0
    buffer_load_dwordx4 v16, s[84:87], s24 offen lds
    s_add_u32 m0, s25, 3072
    s_nop 0
    buffer_load_dwordx4 v17, s[84:87], s24 offen lds
    s_add_u32 m0, s25, 4096
    s_nop 0
    buffer_load_dwordx4 v18, s[84:87], s24 offen lds
    s_add_u32 s25, s25, 5120
    s_add_u32 s24, s24, 51200
    s_cmp_eq_u32 s24, 819200
    s_cselect_b32 s24, 0, s24
    s_add_u32 m0, s27, 0
    s_mov_b64 exec, s[40:41]
    buffer_load_dwordx4 v8, s[8:11], s21 offen offset:1024 sc1 lds
    buffer_load_dwordx4 v8, s[8:11], s21 offen offset:2048 sc1 lds
    s_mov_b64 exec, s[42:43]
    buffer_load_dwordx4 v8, s[8:11], s21 offen offset:3072 sc1 lds
    s_mov_b64 exec, -1
    buffer_load_dwordx4 v8, s[8:11], s21 offen sc1 lds
    s_add_u32 s4, s21, 212992
    s_add_u32 m0, s27, 3344
    s_mov_b64 exec, s[40:41]
    buffer_load_dwordx4 v8, s[8:11], s4 offen offset:1024 sc1 lds
    buffer_load_dwordx4 v8, s[8:11], s4 offen offset:2048 sc1 lds
    s_mov_b64 exec, s[42:43]
    buffer_load_dwordx4 v8, s[8:11], s4 offen offset:3072 sc1 lds
    s_mov_b64 exec, -1
    buffer_load_dwordx4 v8, s[8:11], s4 offen sc1 lds
    s_add_u32 s4, s21, 425984
    s_add_u32 m0, s27, 6688
    s_mov_b64 exec, s[40:41]
    buffer_load_dwordx4 v8, s[8:11], s4 offen offset:1024 sc1 lds
    buffer_load_dwordx4 v8, s[8:11], s4 offen offset:2048 sc1 lds
    s_mov_b64 exec, s[42:43]
    buffer_load_dwordx4 v8, s[8:11], s4 offen offset:3072 sc1 lds
    s_mov_b64 exec, -1
    buffer_load_dwordx4 v8, s[8:11], s4 offen sc1 lds
    s_add_u32 s4, s21, 638976
    s_add_u32 m0, s27, 10032
    s_mov_b64 exec, s[40:41]
    buffer_load_dwordx4 v8, s[8:11], s4 offen offset:1024 sc1 lds
    buffer_load_dwordx4 v8, s[8:11], s4 offen offset:2048 sc1 lds
    s_mov_b64 exec, s[42:43]
    buffer_load_dwordx4 v8, s[8:11], s4 offen offset:3072 sc1 lds
    s_mov_b64 exec, -1
    buffer_load_dwordx4 v8, s[8:11], s4 offen sc1 lds
    s_add_u32 s21, s21, 3328
    s_add_u32 s27, s27, 13376
    s_cmp_eq_u32 s27, 107008
    s_cselect_b32 s27, 0, s27
    s_add_u32 m0, s27, 0
    s_mov_b64 exec, s[40:41]
    buffer_load_dwordx4 v8, s[8:11], s21 offen offset:1024 sc1 lds
    buffer_load_dwordx4 v8, s[8:11], s21 offen offset:2048 sc1 lds
    s_mov_b64 exec, s[42:43]
    buffer_load_dwordx4 v8, s[8:11], s21 offen offset:3072 sc1 lds
    s_mov_b64 exec, -1
    buffer_load_dwordx4 v8, s[8:11], s21 offen sc1 lds
    s_add_u32 s4, s21, 212992
    s_add_u32 m0, s27, 3344
    s_mov_b64 exec, s[40:41]
    buffer_load_dwordx4 v8, s[8:11], s4 offen offset:1024 sc1 lds
    buffer_load_dwordx4 v8, s[8:11], s4 offen offset:2048 sc1 lds
    s_mov_b64 exec, s[42:43]
    buffer_load_dwordx4 v8, s[8:11], s4 offen offset:3072 sc1 lds
    s_mov_b64 exec, -1
    buffer_load_dwordx4 v8, s[8:11], s4 offen sc1 lds
    s_add_u32 s4, s21, 425984
    s_add_u32 m0, s27, 6688
    s_mov_b64 exec, s[40:41]
    buffer_load_dwordx4 v8, s[8:11], s4 offen offset:1024 sc1 lds
    buffer_load_dwordx4 v8, s[8:11], s4 offen offset:2048 sc1 lds
    s_mov_b64 exec, s[42:43]
    buffer_load_dwordx4 v8, s[8:11], s4 offen offset:3072 sc1 lds
    s_mov_b64 exec, -1
    buffer_load_dwordx4 v8, s[8:11], s4 offen sc1 lds
    s_add_u32 s4, s21, 638976
    s_add_u32 m0, s27, 10032
    s_mov_b64 exec, s[40:41]
    buffer_load_dwordx4 v8, s[8:11], s4 offen offset:1024 sc1 lds
    buffer_load_dwordx4 v8, s[8:11], s4 offen offset:2048 sc1 lds
    s_mov_b64 exec, s[42:43]
    buffer_load_dwordx4 v8, s[8:11], s4 offen offset:3072 sc1 lds
    s_mov_b64 exec, -1
    buffer_load_dwordx4 v8, s[8:11], s4 offen sc1 lds
    s_add_u32 s21, s21, 3328
    s_add_u32 s27, s27, 13376
    s_cmp_eq_u32 s27, 107008
    s_cselect_b32 s27, 0, s27
    s_add_u32 s34, s34, 1
    s_cmp_lt_u32 s34, 12
    s_cbranch_scc1 L_pA_w
L_pA_n:
    s_waitcnt vmcnt(32)
    s_barrier
    s_add_u32 m0, s27, 0
    s_mov_b64 exec, s[40:41]
    buffer_load_dwordx4 v8, s[8:11], s21 offen offset:1024 sc1 lds
    buffer_load_dwordx4 v8, s[8:11], s21 offen offset:2048 sc1 lds
    s_mov_b64 exec, s[42:43]
    buffer_load_dwordx4 v8, s[8:11], s21 offen offset:3072 sc1 lds
    s_mov_b64 exec, -1
    buffer_load_dwordx4 v8, s[8:11], s21 offen sc1 lds
    s_add_u32 s4, s21, 212992
    s_add_u32 m0, s27, 3344
    s_mov_b64 exec, s[40:41]
    buffer_load_dwordx4 v8, s[8:11], s4 offen offset:1024 sc1 lds
    buffer_load_dwordx4 v8, s[8:11], s4 offen offset:2048 sc1 lds
    s_mov_b64 exec, s[42:43]
    buffer_load_dwordx4 v8, s[8:11], s4 offen offset:3072 sc1 lds
    s_mov_b64 exec, -1
    buffer_load_dwordx4 v8, s[8:11], s4 offen sc1 lds
    s_add_u32 s4, s21, 425984
    s_add_u32 m0, s27, 6688
    s_mov_b64 exec, s[40:41]
    buffer_load_dwordx4 v8, s[8:11], s4 offen offset:1024 sc1 lds
    buffer_load_dwordx4 v8, s[8:11], s4 offen offset:2048 sc1 lds
    s_mov_b64 exec, s[42:43]
    buffer_load_dwordx4 v8, s[8:11], s4 offen offset:3072 sc1 lds
    s_mov_b64 exec, -1
    buffer_load_dwordx4 v8, s[8:11], s4 offen sc1 lds
    s_add_u32 s4, s21, 638976
    s_add_u32 m0, s27, 10032
    s_mov_b64 exec, s[40:41]
    buffer_load_dwordx4 v8, s[8:11], s4 offen offset:1024 sc1 lds
    buffer_load_dwordx4 v8, s[8:11], s4 offen offset:2048 sc1 lds
    s_mov_b64 exec, s[42:43]
    buffer_load_dwordx4 v8, s[8:11], s4 offen offset:3072 sc1 lds
    s_mov_b64 exec, -1
    buffer_load_dwordx4 v8, s[8:11], s4 offen sc1 lds
    s_add_u32 s21, s21, 3328
    s_add_u32 s27, s27, 13376
    s_cmp_eq_u32 s27, 107008
    s_cselect_b32 s27, 0, s27
    s_add_u32 m0, s27, 0
    s_mov_b64 exec, s[40:41]
    buffer_load_dwordx4 v8, s[8:11], s21 offen offset:1024 sc1 lds
    buffer_load_dwordx4 v8, s[8:11], s21 offen offset:2048 sc1 lds
    s_mov_b64 exec, s[42:43]
    buffer_load_dwordx4 v8, s[8:11], s21 offen offset:3072 sc1 lds
    s_mov_b64 exec, -1
    buffer_load_dwordx4 v8, s[8:11], s21 offen sc1 lds
    s_add_u32 s4, s21, 212992
    s_add_u32 m0, s27, 3344
    s_mov_b64 exec, s[40:41]
    buffer_load_dwordx4 v8, s[8:11], s4 offen offset:1024 sc1 lds
    buffer_load_dwordx4 v8, s[8:11], s4 offen offset:2048 sc1 lds
    s_mov_b64 exec, s[42:43]
    buffer_load_dwordx4 v8, s[8:11], s4 offen offset:3072 sc1 lds
    s_mov_b64 exec, -1
    buffer_load_dwordx4 v8, s[8:11], s4 offen sc1 lds
    s_add_u32 s4, s21, 425984
    s_add_u32 m0, s27, 6688
    s_mov_b64 exec, s[40:41]
    buffer_load_dwordx4 v8, s[8:11], s4 offen offset:1024 sc1 lds
    buffer_load_dwordx4 v8, s[8:11], s4 offen offset:2048 sc1 lds
    s_mov_b64 exec, s[42:43]
    buffer_load_dwordx4 v8, s[8:11], s4 offen offset:3072 sc1 lds
    s_mov_b64 exec, -1
    buffer_load_dwordx4 v8, s[8:11], s4 offen sc1 lds
    s_add_u32 s4, s21, 638976
    s_add_u32 m0, s27, 10032
    s_mov_b64 exec, s[40:41]
    buffer_load_dwordx4 v8, s[8:11], s4 offen offset:1024 sc1 lds
    buffer_load_dwordx4 v8, s[8:11], s4 offen offset:2048 sc1 lds
    s_mov_b64 exec, s[42:43]
    buffer_load_dwordx4 v8, s[8:11], s4 offen offset:3072 sc1 lds
    s_mov_b64 exec, -1
    buffer_load_dwordx4 v8, s[8:11], s4 offen sc1 lds
    s_add_u32 s21, s21, 3328
    s_add_u32 s27, s27, 13376
    s_cmp_eq_u32 s27, 107008
    s_cselect_b32 s27, 0, s27
    s_add_u32 s34, s34, 1
    s_cmp_lt_u32 s34, 28
    s_cbranch_scc1 L_pA_n
    s_waitcnt vmcnt(32)
    s_barrier
    s_add_u32 m0, s27, 0
    s_mov_b64 exec, s[40:41]
    buffer_load_dwordx4 v8, s[8:11], s21 offen offset:1024 sc1 lds
    buffer_load_dwordx4 v8, s[8:11], s21 offen offset:2048 sc1 lds
    s_mov_b64 exec, s[42:43]
    buffer_load_dwordx4 v8, s[8:11], s21 offen offset:3072 sc1 lds
    s_mov_b64 exec, -1
    buffer_load_dwordx4 v8, s[8:11], s21 offen sc1 lds
    s_add_u32 s4, s21, 212992
    s_add_u32 m0, s27, 3344
    s_mov_b64 exec, s[40:41]
    buffer_load_dwordx4 v8, s[8:11], s4 offen offset:1024 sc1 lds
    buffer_load_dwordx4 v8, s[8:11], s4 offen offset:2048 sc1 lds
    s_mov_b64 exec, s[42:43]
    buffer_load_dwordx4 v8, s[8:11], s4 offen offset:3072 sc1 lds
    s_mov_b64 exec, -1
    buffer_load_dwordx4 v8, s[8:11], s4 offen sc1 lds
    s_add_u32 s4, s21, 425984
    s_add_u32 m0, s27, 6688
    s_mov_b64 exec, s[40:41]
    buffer_load_dwordx4 v8, s[8:11], s4 offen offset:1024 sc1 lds
    buffer_load_dwordx4 v8, s[8:11], s4 offen offset:2048 sc1 lds
    s_mov_b64 exec, s[42:43]
    buffer_load_dwordx4 v8, s[8:11], s4 offen offset:3072 sc1 lds
    s_mov_b64 exec, -1
    buffer_load_dwordx4 v8, s[8:11], s4 offen sc1 lds
    s_add_u32 s4, s21, 638976
    s_add_u32 m0, s27, 10032
    s_mov_b64 exec, s[40:41]
    buffer_load_dwordx4 v8, s[8:11], s4 offen offset:1024 sc1 lds
    buffer_load_dwordx4 v8, s[8:11], s4 offen offset:2048 sc1 lds
    s_mov_b64 exec, s[42:43]
    buffer_load_dwordx4 v8, s[8:11], s4 offen offset:3072 sc1 lds
    s_mov_b64 exec, -1
    buffer_load_dwordx4 v8, s[8:11], s4 offen sc1 lds
    s_add_u32 s21, s21, 3328
    s_add_u32 s27, s27, 13376
    s_cmp_eq_u32 s27, 107008
    s_cselect_b32 s27, 0, s27
    s_waitcnt vmcnt(16)
    s_barrier
    s_waitcnt vmcnt(0)
    s_barrier
    s_branch L_pend
L_pB:
    s_barrier
    s_add_u32 m0, s27, 0
    s_mov_b64 exec, s[40:41]
    buffer_load_dwordx4 v8, s[8:11], s21 offen offset:1024 sc1 lds
    buffer_load_dwordx4 v8, s[8:11], s21 offen offset:2048 sc1 lds
    s_mov_b64 exec, s[42:43]
    buffer_load_dwordx4 v8, s[8:11], s21 offen offset:3072 sc1 lds
    s_mov_b64 exec, -1
    buffer_load_dwordx4 v8, s[8:11], s21 offen sc1 lds
    s_add_u32 s21, s21, 3328
    s_add_u32 s27, s27, 13376
    s_cmp_eq_u32 s27, 107008
    s_cselect_b32 s27, 0, s27
    s_add_u32 m0, s27, 0
    s_mov_b64 exec, s[40:41]
    buffer_load_dwordx4 v8, s[8:11], s21 offen offset:1024 sc1 lds
    buffer_load_dwordx4 v8, s[8:11], s21 offen offset:2048 sc1 lds
    s_mov_b64 exec, s[42:43]
    buffer_load_dwordx4 v8, s[8:11], s21 offen offset:3072 sc1 lds
    s_mov_b64 exec, -1
    buffer_load_dwordx4 v8, s[8:11], s21 offen sc1 lds
    s_add_u32 s21, s21, 3328
    s_add_u32 s27, s27, 13376
    s_cmp_eq_u32 s27, 107008
    s_cselect_b32 s27, 0, s27
    ds_read_b128 v[56:59], v11 offset:0
    ds_read_b128 v[60:63], v11 offset:1024
    ds_read_b128 v[64:67], v11 offset:2048
    ds_read_b128 v[68:71], v11 offset:3072
    ds_read_b128 v[72:75], v11 offset:4096
    ds_read_b128 v[76:79], v11 offset:5120
    ds_read_b128 v[80:83], v11 offset:6144
    ds_read_b128 v[84:87], v11 offset:7168
    ds_read_b128 v[88:91], v11 offset:8192
    ds_read_b128 v[92:95], v11 offset:9216
    s_waitcnt lgkmcnt(9)
    s_add_u32 s6, s26, 0
    buffer_store_dwordx4 v[56:59], v32, s[8:11], s6 offen sc1
    s_waitcnt lgkmcnt(8)
    buffer_store_dwordx4 v[60:63], v33, s[8:11], s6 offen sc1
    s_waitcnt lgkmcnt(7)
    buffer_store_dwordx4 v[64:67], v34, s[8:11], s6 offen sc1
    s_waitcnt lgkmcnt(6)
    buffer_store_dwordx4 v[68:71], v35, s[8:11], s6 offen sc1
    s_waitcnt lgkmcnt(5)
    buffer_store_dwordx4 v[72:75], v36, s[8:11], s6 offen sc1
    s_waitcnt lgkmcnt(4)
    s_add_u32 s6, s26, 212992
    buffer_store_dwordx4 v[76:79], v32, s[8:11], s6 offen sc1
    s_waitcnt lgkmcnt(3)
    buffer_store_dwordx4 v[80:83], v33, s[8:11], s6 offen sc1
    s_waitcnt lgkmcnt(2)
    buffer_store_dwordx4 v[84:87], v34, s[8:11], s6 offen sc1
    s_waitcnt lgkmcnt(1)
    buffer_store_dwordx4 v[88:91], v35, s[8:11], s6 offen sc1
    s_waitcnt lgkmcnt(0)
    buffer_store_dwordx4 v[92:95], v36, s[8:11], s6 offen sc1
    ds_read_b128 v[96:99], v11 offset:10240
    ds_read_b128 v[100:103], v11 offset:11264
    ds_read_b128 v[104:107], v11 offset:12288
    ds_read_b128 v[108:111], v11 offset:13312
    ds_read_b128 v[112:115], v11 offset:14336
    ds_read_b128 v[116:119], v11 offset:15360
    ds_read_b128 v[120:123], v11 offset:16384
    ds_read_b128 v[124:127], v11 offset:17408
    ds_read_b128 v[128:131], v11 offset:18432
    ds_read_b128 v[132:135], v11 offset:19456
    s_waitcnt lgkmcnt(9)
    s_add_u32 s6, s26, 425984
    buffer_store_dwordx4 v[96:99], v32, s[8:11], s6 offen sc1
    s_waitcnt lgkmcnt(8)
    buffer_store_dwordx4 v[100:103], v33, s[8:11], s6 offen sc1
    s_waitcnt lgkmcnt(7)
    buffer_store_dwordx4 v[104:107], v34, s[8:11], s6 offen sc1
    s_waitcnt lgkmcnt(6)
    buffer_store_dwordx4 v[108:111], v35, s[8:11], s6 offen sc1
    s_waitcnt lgkmcnt(5)
    buffer_store_dwordx4 v[112:115], v36, s[8:11], s6 offen sc1
    s_waitcnt lgkmcnt(4)
    s_add_u32 s6, s26, 638976
    buffer_store_dwordx4 v[116:119], v32, s[8:11], s6 offen sc1
    s_waitcnt lgkmcnt(3)
    buffer_store_dwordx4 v[120:123], v33, s[8:11], s6 offen sc1
    s_waitcnt lgkmcnt(2)
    buffer_store_dwordx4 v[124:127], v34, s[8:11], s6 offen sc1
    s_waitcnt lgkmcnt(1)
    buffer_store_dwordx4 v[128:131], v35, s[8:11], s6 offen sc1
    s_waitcnt lgkmcnt(0)
    buffer_store_dwordx4 v[132:135], v36, s[8:11], s6 offen sc1
    s_mov_b32 s34, 1
L_pBq_w:
    s_waitcnt vmcnt(8)
    s_barrier
    s_cmp_lg_u32 s34, 2
    s_cbranch_scc1 L_pBq_h
    s_add_u32 s4, s32, 16
    s_lshl_b32 s3, s4, 8
    s_add_u32 s3, s3, 17563648
    v_mov_b32 v4, 0
    v_mov_b32 v5, 1
    s_mov_b64 exec, 1
    buffer_atomic_add v5, v4, s[8:11], s3 offen sc1
    s_mov_b64 exec, -1
L_pBq_h:
    s_add_u32 m0, s25, 0
    s_nop 0
    buffer_load_dwordx4 v14, s[84:87], s24 offen lds
    s_add_u32 m0, s25, 1024
    s_nop 0
    buffer_load_dwordx4 v15, s[84:87], s24 offen lds
    s_add_u32 m0, s25, 2048
    s_nop 0
    buffer_load_dwordx4 v16, s[84:87], s24 offen lds
    s_add_u32 m0, s25, 3072
    s_nop 0
    buffer_load_dwordx4 v17, s[84:87], s24 offen lds
    s_add_u32 m0, s25, 4096
    s_nop 0
    buffer_load_dwordx4 v18, s[84:87], s24 offen lds
    s_add_u32 s25, s25, 5120
    s_add_u32 s24, s24, 51200
    s_cmp_eq_u32 s24, 819200
    s_cselect_b32 s24, 0, s24
    s_add_u32 m0, s27, 0
    s_mov_b64 exec, s[40:41]
    buffer_load_dwordx4 v8, s[8:11], s21 offen offset:1024 sc1 lds
    buffer_load_dwordx4 v8, s[8:11], s21 offen offset:2048 sc1 lds
    s_mov_b64 exec, s[42:43]
    buffer_load_dwordx4 v8, s[8:11], s21 offen offset:3072 sc1 lds
    s_mov_b64 exec, -1
    buffer_load_dwordx4 v8, s[8:11], s21 offen sc1 lds
    s_add_u32 s21, s21, 3328
    s_add_u32 s27, s27, 13376
    s_cmp_eq_u32 s27, 107008
    s_cselect_b32 s27, 0, s27
    s_add_u32 m0, s27, 0
    s_mov_b64 exec, s[40:41]
    buffer_load_dwordx4 v8, s[8:11], s21 offen offset:1024 sc1 lds
    buffer_load_dwordx4 v8, s[8:11], s21 offen offset:2048 sc1 lds
    s_mov_b64 exec, s[42:43]
    buffer_load_dwordx4 v8, s[8:11], s21 offen offset:3072 sc1 lds
    s_mov_b64 exec, -1
    buffer_load_dwordx4 v8, s[8:11], s21 offen sc1 lds
    s_add_u32 s21, s21, 3328
    s_add_u32 s27, s27, 13376
    s_cmp_eq_u32 s27, 107008
    s_cselect_b32 s27, 0, s27
    s_add_u32 s34, s34, 1
    s_cmp_lt_u32 s34, 12
    s_cbranch_scc1 L_pBq_w
L_pBq_n:
    s_waitcnt vmcnt(8)
    s_barrier
    s_add_u32 m0, s27, 0
    s_mov_b64 exec, s[40:41]
    buffer_load_dwordx4 v8, s[8:11], s21 offen offset:1024 sc1 lds
    buffer_load_dwordx4 v8, s[8:11], s21 offen offset:2048 sc1 lds
    s_mov_b64 exec, s[42:43]
    buffer_load_dwordx4 v8, s[8:11], s21 offen offset:3072 sc1 lds
    s_mov_b64 exec, -1
    buffer_load_dwordx4 v8, s[8:11], s21 offen sc1 lds
    s_add_u32 s21, s21, 3328
    s_add_u32 s27, s27, 13376
    s_cmp_eq_u32 s27, 107008
    s_cselect_b32 s27, 0, s27
    s_add_u32 m0, s27, 0
    s_mov_b64 exec, s[40:41]
    buffer_load_dwordx4 v8, s[8:11], s21 offen offset:1024 sc1 lds
    buffer_load_dwordx4 v8, s[8:11], s21 offen offset:2048 sc1 lds
    s_mov_b64 exec, s[42:43]
    buffer_load_dwordx4 v8, s[8:11], s21 offen offset:3072 sc1 lds
    s_mov_b64 exec, -1
    buffer_load_dwordx4 v8, s[8:11], s21 offen sc1 lds
    s_add_u32 s21, s21, 3328
    s_add_u32 s27, s27, 13376
    s_cmp_eq_u32 s27, 107008
    s_cselect_b32 s27, 0, s27
    s_add_u32 s34, s34, 1
    s_cmp_lt_u32 s34, 28
    s_cbranch_scc1 L_pBq_n
    s_waitcnt vmcnt(8)
    s_barrier
    s_add_u32 m0, s27, 0
    s_mov_b64 exec, s[40:41]
    buffer_load_dwordx4 v8, s[8:11], s21 offen offset:1024 sc1 lds
    buffer_load_dwordx4 v8, s[8:11], s21 offen offset:2048 sc1 lds
    s_mov_b64 exec, s[42:43]
    buffer_load_dwordx4 v8, s[8:11], s21 offen offset:3072 sc1 lds
    s_mov_b64 exec, -1
    buffer_load_dwordx4 v8, s[8:11], s21 offen sc1 lds
    s_add_u32 s21, s21, 3328
    s_add_u32 s27, s27, 13376
    s_cmp_eq_u32 s27, 107008
    s_cselect_b32 s27, 0, s27
    s_waitcnt vmcnt(4)
    s_barrier
    s_waitcnt vmcnt(0)
    s_barrier
L_pend:
    s_mov_b32 s25, 0
    s_add_u32 m0, s25, 0
    s_nop 0
    buffer_load_dwordx4 v14, s[84:87], s24 offen lds
    s_add_u32 m0, s25, 1024
    s_nop 0
    buffer_load_dwordx4 v15, s[84:87], s24 offen lds
    s_add_u32 m0, s25, 2048
    s_nop 0
    buffer_load_dwordx4 v16, s[84:87], s24 offen lds
    s_add_u32 m0, s25, 3072
    s_nop 0
    buffer_load_dwordx4 v17, s[84:87], s24 offen lds
    s_add_u32 m0, s25, 4096
    s_nop 0
    buffer_load_dwordx4 v18, s[84:87], s24 offen lds
    s_add_u32 s25, s25, 5120
    s_add_u32 s24, s24, 51200
    s_cmp_eq_u32 s24, 819200
    s_cselect_b32 s24, 0, s24
    s_add_u32 m0, s25, 0
    s_nop 0
    buffer_load_dwordx4 v14, s[84:87], s24 offen lds
    s_add_u32 m0, s25, 1024
    s_nop 0
    buffer_load_dwordx4 v15, s[84:87], s24 offen lds
    s_add_u32 m0, s25, 2048
    s_nop 0
    buffer_load_dwordx4 v16, s[84:87], s24 offen lds
    s_add_u32 m0, s25, 3072
    s_nop 0
    buffer_load_dwordx4 v17, s[84:87], s24 offen lds
    s_add_u32 m0, s25, 4096
    s_nop 0
    buffer_load_dwordx4 v18, s[84:87], s24 offen lds
    s_add_u32 s25, s25, 5120
    s_add_u32 s24, s24, 51200
    s_cmp_eq_u32 s24, 819200
    s_cselect_b32 s24, 0, s24
    s_add_u32 m0, s25, 0
    s_nop 0
    buffer_load_dwordx4 v14, s[84:87], s24 offen lds
    s_add_u32 m0, s25, 1024
    s_nop 0
    buffer_load_dwordx4 v15, s[84:87], s24 offen lds
    s_add_u32 m0, s25, 2048
    s_nop 0
    buffer_load_dwordx4 v16, s[84:87], s24 offen lds
    s_add_u32 m0, s25, 3072
    s_nop 0
    buffer_load_dwordx4 v17, s[84:87], s24 offen lds
    s_add_u32 m0, s25, 4096
    s_nop 0
    buffer_load_dwordx4 v18, s[84:87], s24 offen lds
    s_add_u32 s25, s25, 5120
    s_add_u32 s24, s24, 51200
    s_cmp_eq_u32 s24, 819200
    s_cselect_b32 s24, 0, s24
    s_add_u32 m0, s25, 0
    s_nop 0
    buffer_load_dwordx4 v14, s[84:87], s24 offen lds
    s_add_u32 m0, s25, 1024
    s_nop 0
    buffer_load_dwordx4 v15, s[84:87], s24 offen lds
    s_add_u32 m0, s25, 2048
    s_nop 0
    buffer_load_dwordx4 v16, s[84:87], s24 offen lds
    s_add_u32 m0, s25, 3072
    s_nop 0
    buffer_load_dwordx4 v17, s[84:87], s24 offen lds
    s_add_u32 m0, s25, 4096
    s_nop 0
    buffer_load_dwordx4 v18, s[84:87], s24 offen lds
    s_add_u32 s25, s25, 5120
    s_add_u32 s24, s24, 51200
    s_cmp_eq_u32 s24, 819200
    s_cselect_b32 s24, 0, s24
    s_add_u32 m0, s25, 0
    s_nop 0
    buffer_load_dwordx4 v14, s[84:87], s24 offen lds
    s_add_u32 m0, s25, 1024
    s_nop 0
    buffer_load_dwordx4 v15, s[84:87], s24 offen lds
    s_add_u32 m0, s25, 2048
    s_nop 0
    buffer_load_dwordx4 v16, s[84:87], s24 offen lds
    s_add_u32 m0, s25, 3072
    s_nop 0
    buffer_load_dwordx4 v17, s[84:87], s24 offen lds
    s_add_u32 m0, s25, 4096
    s_nop 0
    buffer_load_dwordx4 v18, s[84:87], s24 offen lds
    s_add_u32 s25, s25, 5120
    s_add_u32 s24, s24, 51200
    s_cmp_eq_u32 s24, 819200
    s_cselect_b32 s24, 0, s24
    s_barrier
    s_mov_b32 s24, 0
    s_add_u32 m0, s25, 0
    s_nop 0
    buffer_load_dwordx4 v19, s[84:87], s24 offen lds
    s_add_u32 m0, s25, 1024
    s_nop 0
    buffer_load_dwordx4 v20, s[84:87], s24 offen lds
    s_add_u32 m0, s25, 2048
    s_nop 0
    buffer_load_dwordx4 v21, s[84:87], s24 offen lds
    s_add_u32 m0, s25, 3072
    s_nop 0
    buffer_load_dwordx4 v22, s[84:87], s24 offen lds
    s_add_u32 m0, s25, 4096
    s_nop 0
    buffer_load_dwordx4 v23, s[84:87], s24 offen lds
    s_add_u32 s25, s25, 5120
    s_add_u32 s24, s24, 204800
    s_add_u32 m0, s25, 0
    s_nop 0
    buffer_load_dwordx4 v19, s[84:87], s24 offen lds
    s_add_u32 m0, s25, 1024
    s_nop 0
    buffer_load_dwordx4 v20, s[84:87], s24 offen lds
    s_add_u32 m0, s25, 2048
    s_nop 0
    buffer_load_dwordx4 v21, s[84:87], s24 offen lds
    s_add_u32 m0, s25, 3072
    s_nop 0
    buffer_load_dwordx4 v22, s[84:87], s24 offen lds
    s_add_u32 m0, s25, 4096
    s_nop 0
    buffer_load_dwordx4 v23, s[84:87], s24 offen lds
    s_add_u32 s25, s25, 5120
    s_add_u32 s24, s24, 204800
    s_add_u32 m0, s25, 0
    s_nop 0
    buffer_load_dwordx4 v19, s[84:87], s24 offen lds
    s_add_u32 m0, s25, 1024
    s_nop 0
    buffer_load_dwordx4 v20, s[84:87], s24 offen lds
    s_add_u32 m0, s25, 2048
    s_nop 0
    buffer_load_dwordx4 v21, s[84:87], s24 offen lds
    s_add_u32 m0, s25, 3072
    s_nop 0
    buffer_load_dwordx4 v22, s[84:87], s24 offen lds
    s_add_u32 m0, s25, 4096
    s_nop 0
    buffer_load_dwordx4 v23, s[84:87], s24 offen lds
    s_add_u32 s25, s25, 5120
    s_add_u32 s24, s24, 204800
    s_add_u32 m0, s25, 0
    s_nop 0
    buffer_load_dwordx4 v19, s[84:87], s24 offen lds
    s_add_u32 m0, s25, 1024
    s_nop 0
    buffer_load_dwordx4 v20, s[84:87], s24 offen lds
    s_add_u32 m0, s25, 2048
    s_nop 0
    buffer_load_dwordx4 v21, s[84:87], s24 offen lds
    s_add_u32 m0, s25, 3072
    s_nop 0
    buffer_load_dwordx4 v22, s[84:87], s24 offen lds
    s_add_u32 m0, s25, 4096
    s_nop 0
    buffer_load_dwordx4 v23, s[84:87], s24 offen lds
    s_add_u32 s25, s25, 5120
    s_add_u32 s24, s24, 204800
    s_lshl_b32 s4, s13, 4
    s_add_u32 s4, s4, s15
    s_add_u32 s4, s4, 40
    s_lshl_b32 s5, s4, 8
    s_add_u32 s5, s5, 17563648
    v_mov_b32 v6, s5
    s_barrier
    s_lshl_b32 s3, s4, 8
    s_add_u32 s3, s3, 17563648
    v_mov_b32 v4, 0
    v_mov_b32 v5, 1
    s_mov_b64 exec, 1
    buffer_atomic_add v5, v4, s[8:11], s3 offen sc1
    s_mov_b64 exec, -1
    s_mov_b64 exec, 1
    s_mov_b32 s3, 0
L_poll2:
    buffer_load_dword v7, v6, s[8:11], 0 offen sc1
    s_waitcnt vmcnt(0)
    v_cmp_ne_u32 vcc, 8, v7
    s_add_u32 s3, s3, 1
    s_cmp_gt_u32 s3, 60000
    s_cbranch_scc1 L_poll2_t
    s_cbranch_vccz L_poll2_d
    s_sleep 2
    s_branch L_poll2
L_poll2_t:
L_poll2_d:
    s_mov_b64 exec, -1
    s_barrier
    s_endpgm
L_attn_slow:
    v_cndmask_b32 v156, v156, 0, s[44:45]
    v_cndmask_b32 v157, v157, 0, s[44:45]
    v_cndmask_b32 v158, v158, 0, s[44:45]
    v_cndmask_b32 v159, v159, 0, s[44:45]
    v_and_b32 v7, 31, v1
    v_cmp_eq_u32 s[46:47], 20, v7
    v_mov_b32 v9, 0x3f803f80
    v_mov_b32 v11, 0x3f80
    v_mov_b32 v14, 0xff800000
    v_mov_b32 v15, 0xff800000
    s_mov_b32 s21, s20
    s_mov_b32 s34, 0
L_attn_slow1:
    buffer_load_dwordx4 v[20:23], v8, s[8:11], s21 offen sc1
    buffer_load_dwordx2 v[16:17], v13, s[8:11], s21 offen offset:3072 sc1
    s_waitcnt vmcnt(0)
    v_cndmask_b32 v16, v16, v9, s[44:45]
    v_cndmask_b32 v17, v17, v11, s[44:45]
    s_nop 1
    v_mfma_f32_32x32x16_bf16 v[52:67], v[20:23], v[148:151], 0
    v_mfma_f32_32x32x8_bf16 v[52:67], v[16:17], v[156:157], v[52:67]
    v_mfma_f32_32x32x16_bf16 v[68:83], v[20:23], v[152:155], 0
    v_mfma_f32_32x32x8_bf16 v[68:83], v[16:17], v[158:159], v[68:83]
    s_nop 7
    s_nop 7
    v_max3_f32 v14, v14, v52, v53
    v_max3_f32 v14, v14, v54, v55
    v_max3_f32 v14, v14, v56, v57
    v_max3_f32 v14, v14, v58, v59
    v_max3_f32 v14, v14, v60, v61
    v_max3_f32 v14, v14, v62, v63
    v_max3_f32 v14, v14, v64, v65
    v_max3_f32 v14, v14, v66, v67
    v_max3_f32 v15, v15, v68, v69
    v_max3_f32 v15, v15, v70, v71
    v_max3_f32 v15, v15, v72, v73
    v_max3_f32 v15, v15, v74, v75
    v_max3_f32 v15, v15, v76, v77
    v_max3_f32 v15, v15, v78, v79
    v_max3_f32 v15, v15, v80, v81
    v_max3_f32 v15, v15, v82, v83
    s_add_u32 s21, s21, 3328
    s_add_u32 s34, s34, 1
    s_cmp_lt_u32 s34, 64
    s_cbranch_scc1 L_attn_slow1
    v_mov_b32 v4, v14
    s_nop 1
    v_permlane32_swap_b32 v14, v4
    s_nop 1
    v_max_f32 v4, v14, v4
    v_sub_f32 v4, 0, v4
    v_and_b32 v5, 0xffff0000, v4
    v_sub_f32 v4, v4, v5
    v_and_b32 v6, 0xffff0000, v4
    v_sub_f32 v4, v4, v6
    s_mov_b32 s3, 0x07060302
    v_perm_b32 v5, v6, v5, s3
    v_lshrrev_b32 v4, 16, v4
    v_cndmask_b32 v156, v156, v5, s[44:45]
    v_cndmask_b32 v157, v157, v4, s[44:45]
    v_mov_b32 v4, v15
    s_nop 1
    v_permlane32_swap_b32 v15, v4
    s_nop 1
    v_max_f32 v4, v15, v4
    v_sub_f32 v4, 0, v4
    v_and_b32 v5, 0xffff0000, v4
    v_sub_f32 v4, v4, v5
    v_and_b32 v6, 0xffff0000, v4
    v_sub_f32 v4, v4, v6
    s_mov_b32 s3, 0x07060302
    v_perm_b32 v5, v6, v5, s3
    v_lshrrev_b32 v4, 16, v4
    v_cndmask_b32 v158, v158, v5, s[44:45]
    v_cndmask_b32 v159, v159, v4, s[44:45]
    v_mov_b32 v84, 0
    v_mov_b32 v100, 0
    v_mov_b32 v85, 0
    v_mov_b32 v101, 0
    v_mov_b32 v86, 0
    v_mov_b32 v102, 0
    v_mov_b32 v87, 0
    v_mov_b32 v103, 0
    v_mov_b32 v88, 0
    v_mov_b32 v104, 0
    v_mov_b32 v89, 0
    v_mov_b32 v105, 0
    v_mov_b32 v90, 0
    v_mov_b32 v106, 0
    v_mov_b32 v91, 0
    v_mov_b32 v107, 0
    v_mov_b32 v92, 0
    v_mov_b32 v108, 0
    v_mov_b32 v93, 0
    v_mov_b32 v109, 0
    v_mov_b32 v94, 0
    v_mov_b32 v110, 0
    v_mov_b32 v95, 0
    v_mov_b32 v111, 0
    v_mov_b32 v96, 0
    v_mov_b32 v112, 0
    v_mov_b32 v97, 0
    v_mov_b32 v113, 0
    v_mov_b32 v98, 0
    v_mov_b32 v114, 0
    v_mov_b32 v99, 0
    v_mov_b32 v115, 0
    s_mov_b32 s21, s20
    s_mov_b32 s34, 0
L_attn_slow2:
    buffer_load_dwordx4 v[20:23], v8, s[8:11], s21 offen sc1
    buffer_load_dwordx2 v[16:17], v13, s[8:11], s21 offen offset:3072 sc1
    buffer_load_dwordx4 v[28:31], v8, s[8:11], s21 offen offset:1024 sc1
    buffer_load_dwordx4 v[36:39], v8, s[8:11], s21 offen offset:2048 sc1
    s_waitcnt vmcnt(0)
    v_cndmask_b32 v16, v16, v9, s[44:45]
    v_cndmask_b32 v17, v17, v11, s[44:45]
    v_cndmask_b32 v28, v28, v9, s[46:47]
    v_cndmask_b32 v36, v36, v9, s[46:47]
    v_cndmask_b32 v29, v29, v9, s[46:47]
    v_cndmask_b32 v37, v37, v9, s[46:47]
    v_cndmask_b32 v30, v30, v9, s[46:47]
    v_cndmask_b32 v38, v38, v9, s[46:47]
    v_cndmask_b32 v31, v31, v9, s[46:47]
    v_cndmask_b32 v39, v39, v9, s[46:47]
    s_nop 1
    v_mfma_f32_32x32x16_bf16 v[52:67], v[20:23], v[148:151], 0
    v_mfma_f32_32x32x8_bf16 v[52:67], v[16:17], v[156:157], v[52:67]
    v_mfma_f32_32x32x16_bf16 v[68:83], v[20:23], v[152:155], 0
    v_mfma_f32_32x32x8_bf16 v[68:83], v[16:17], v[158:159], v[68:83]
    s_nop 7
    s_nop 7
    v_exp_f32 v52, v52
    v_exp_f32 v53, v53
    v_exp_f32 v54, v54
    v_exp_f32 v55, v55
    v_exp_f32 v56, v56
    v_exp_f32 v57, v57
    v_exp_f32 v58, v58
    v_exp_f32 v59, v59
    v_exp_f32 v60, v60
    v_exp_f32 v61, v61
    v_exp_f32 v62, v62
    v_exp_f32 v63, v63
    v_exp_f32 v64, v64
    v_exp_f32 v65, v65
    v_exp_f32 v66, v66
    v_exp_f32 v67, v67
    s_nop 0
    v_cvt_pk_bf16_f32 v44, v52, v53
    v_cvt_pk_bf16_f32 v45, v54, v55
    v_cvt_pk_bf16_f32 v46, v56, v57
    v_cvt_pk_bf16_f32 v47, v58, v59
    v_cvt_pk_bf16_f32 v48, v60, v61
    v_cvt_pk_bf16_f32 v49, v62, v63
    v_cvt_pk_bf16_f32 v50, v64, v65
    v_cvt_pk_bf16_f32 v51, v66, v67
    s_nop 1
    v_mfma_f32_32x32x16_bf16 v[84:99], v[28:31], v[44:47], v[84:99]
    v_mfma_f32_32x32x16_bf16 v[84:99], v[36:39], v[48:51], v[84:99]
    v_exp_f32 v68, v68
    v_exp_f32 v69, v69
    v_exp_f32 v70, v70
    v_exp_f32 v71, v71
    v_exp_f32 v72, v72
    v_exp_f32 v73, v73
    v_exp_f32 v74, v74
    v_exp_f32 v75, v75
    v_exp_f32 v76, v76
    v_exp_f32 v77, v77
    v_exp_f32 v78, v78
    v_exp_f32 v79, v79
    v_exp_f32 v80, v80
    v_exp_f32 v81, v81
    v_exp_f32 v82, v82
    v_exp_f32 v83, v83
    s_nop 0
    v_cvt_pk_bf16_f32 v44, v68, v69
    v_cvt_pk_bf16_f32 v45, v70, v71
    v_cvt_pk_bf16_f32 v46, v72, v73
    v_cvt_pk_bf16_f32 v47, v74, v75
    v_cvt_pk_bf16_f32 v48, v76, v77
    v_cvt_pk_bf16_f32 v49, v78, v79
    v_cvt_pk_bf16_f32 v50, v80, v81
    v_cvt_pk_bf16_f32 v51, v82, v83
    s_nop 1
    v_mfma_f32_32x32x16_bf16 v[100:115], v[28:31], v[44:47], v[100:115]
    v_mfma_f32_32x32x16_bf16 v[100:115], v[36:39], v[48:51], v[100:115]
    s_add_u32 s21, s21, 3328
    s_add_u32 s34, s34, 1
    s_cmp_lt_u32 s34, 64
    s_cbranch_scc1 L_attn_slow2
    s_nop 7
    s_nop 7
    v_mov_b32 v14, v92
    v_mov_b32 v4, v92
    s_nop 1
    v_permlane32_swap_b32 v4, v14
    s_nop 1
    v_mov_b32 v15, v108
    v_mov_b32 v4, v108
    s_nop 1
    v_permlane32_swap_b32 v4, v15
    s_nop 1
    s_branch L_attn_fin
L_end:
    s_endpgm
.section .rodata,"a"
.p2align 6
.amdhsa_kernel concat_heads__softmax_full_mha__grouped_kv_mqa__prompt_kernel
    .amdhsa_next_free_vgpr 160
    .amdhsa_next_free_sgpr 102
    .amdhsa_accum_offset 160
    .amdhsa_group_segment_fixed_size 0
    .amdhsa_kernarg_size 88
    .amdhsa_user_sgpr_count 2
    .amdhsa_user_sgpr_kernarg_segment_ptr 1
    .amdhsa_system_sgpr_workgroup_id_x 1
.end_amdhsa_kernel
```
